```python
import torch

def _softmax(x, axis=-1):
    return torch.softmax(x, dim=axis)
def _gelu(x):
    return torch.nn.functional.gelu(x, approximate="tanh")
def _silu(x):
    return torch.nn.functional.silu(x)
def _sigmoid(x):
    return torch.sigmoid(x)
def _layernorm(x, axis=-1, eps=1e-5):
    m = x.mean(dim=axis, keepdim=True)
    v = x.var(dim=axis, keepdim=True, unbiased=False)
    return (x - m) / torch.sqrt(v + eps)
def _scatter_add(tgt, idx, src, axis=0):
    return tgt.clone().index_add_(axis, idx, src)
def _segment_sum(src, seg, n):
    out = torch.zeros((n,) + src.shape[1:], dtype=src.dtype)
    return out.index_add_(0, seg, src)
def _pad(x, pw):
    flat = tuple(v for pair in reversed(pw) for v in pair)
    return torch.nn.functional.pad(x, flat)

kernel_name = 'sequential_preLN__gqa_block_cached__dense_activation_squared_relu__decode'

def setup_inputs():

    _w = (lambda a: (lambda t: t.to(torch.bfloat16) if t.is_floating_point() else t)(torch.as_tensor(a)))
    def _A_setup():
        B, Sq, D = 4, 1, 512
        Hq, Hkv, Sk, Dh = 32, 8, 8192, 128
        assert Hq % Hkv == 0, (Hq, Hkv)
        return {
            "x": _w((lambda *s: torch.randn(*s, dtype=torch.bfloat16) * 0.05)(B, Sq, D)),
            "k_cache": _w((lambda *s: torch.randn(*s, dtype=torch.bfloat16) * 3.2)(B, Hkv, Sk, Dh)),
            "v_cache": _w((lambda *s: torch.randn(*s, dtype=torch.bfloat16) * 0.4)(B, Hkv, Sk, Dh)),
            "wq": _w((lambda *s: torch.randn(*s, dtype=torch.bfloat16) * 3.2)(D, Hq * Dh) * (D ** -0.5)),
            "wo": _w((lambda *s: torch.randn(*s, dtype=torch.bfloat16) * 0.4)(Hq * Dh, D) * ((Hq * Dh) ** -0.5)),
        }
    _A_in = _A_setup()

    def _B_setup():
        B, S, D, F = 4, 1, 512, 1792
        return {
            "x": _w((lambda *s: torch.randn(*s, dtype=torch.bfloat16) * 0.05)(B, S, D)),
            "w1": _w((lambda *s: torch.randn(*s, dtype=torch.bfloat16) * 0.05)(D, F)),
            "b1": _w((lambda *s: torch.randn(*s, dtype=torch.bfloat16) * 0.8)(F)),
            "w2": _w((lambda *s: torch.randn(*s, dtype=torch.bfloat16) * 0.05)(F, D)),
            "b2": _w((lambda *s: torch.randn(*s, dtype=torch.bfloat16) * 3.2)(D)),
        }
    _B_in = _B_setup()

    return {
        "A_x": _A_in["x"],
        "A_k_cache": _A_in["k_cache"],
        "A_v_cache": _A_in["v_cache"],
        "A_wq": _A_in["wq"],
        "A_wo": _A_in["wo"],
        "B_x": _B_in["x"],
        "B_w1": _B_in["w1"],
        "B_b1": _B_in["b1"],
        "B_w2": _B_in["w2"],
        "B_b2": _B_in["b2"],
    }

def reference(A_x, A_k_cache, A_v_cache, A_wq, A_wo, B_x, B_w1, B_b1, B_w2, B_b2):
    def _A_ref(x, k_cache, v_cache, wq, wo):
        B, Sq, D = x.shape
        Hq, Dh = 32, 128
        Hkv = k_cache.shape[1]
        rep = Hq // Hkv
        q = (lambda x, *d: x.permute(*d))((x @ wq).reshape(B, Sq, Hq, Dh), 0, 2, 1, 3)
        k = (lambda x, n, axis: torch.repeat_interleave(x, n, dim=axis))(k_cache, rep, axis=1)
        v = (lambda x, n, axis: torch.repeat_interleave(x, n, dim=axis))(v_cache, rep, axis=1)
        scores = torch.einsum("bhqd,bhkd->bhqk", q, k) * (Dh ** -0.5)
        p = _softmax(scores, axis=-1)
        o = torch.einsum("bhqk,bhkd->bhqd", p, v)
        return (lambda x, *d: x.permute(*d))(o, 0, 2, 1, 3).reshape(B, Sq, Hq * Dh) @ wo

    def _B_ref(x, w1, b1, w2, b2):
        h = torch.einsum("bsd,df->bsf", x, w1) + b1
        zero = torch.zeros_like(h)
        r = torch.where(h > zero, h, zero)
        h = r * r
        out = torch.einsum("bsf,fd->bsd", h, w2) + b2
        return out

    x = A_x
    h = x + _A_ref(_layernorm(x, axis=-1), A_k_cache, A_v_cache, A_wq, A_wo)
    h2 = h + _B_ref(_layernorm(h, axis=-1), B_w1, B_b1, B_w2, B_b2)
    return h2
```

```asm
; @launch grid=(256,1,1) block=(256,1,1) lds=163840
.amdgcn_target "amdgcn-amd-amdhsa--gfx950"
.text
.globl sequential_preLN__gqa_block_cached__dense_activation_squared_relu__decode_kernel
.p2align 8
.type sequential_preLN__gqa_block_cached__dense_activation_squared_relu__decode_kernel,@function
sequential_preLN__gqa_block_cached__dense_activation_squared_relu__decode_kernel:
    s_cmp_ge_u32 s2, 256
    s_cbranch_scc1 L_END
    s_load_dwordx16 s[4:19], s[0:1], 0
    s_load_dwordx2 s[28:29], s[0:1], 96
    s_load_dwordx8 s[20:27], s[0:1], 64
    v_lshrrev_b32 v3, 6, v0
    v_and_b32 v1, 63, v0
    v_readfirstlane_b32 s3, v3
    s_and_b32 s62, s2, 7
    s_lshr_b32 s63, s2, 3
    s_and_b32 s64, s63, 3
    s_lshr_b32 s65, s63, 2
    v_lshrrev_b32 v19, 4, v1
    v_and_b32 v20, 15, v1
    v_and_b32 v21, 3, v1
    v_lshrrev_b32 v4, 2, v1
    v_lshlrev_b32 v2, 4, v1
    v_lshlrev_b32 v3, 4, v0
    v_and_b32 v22, 3, v4
    v_lshlrev_b32 v4, 13, v4
    v_lshl_add_u32 v4, v21, 4, v4
    s_xor_b32 s86, s63, 4
    s_and_b32 s86, s86, 7
    s_bfe_u32 s68, s63, 0x10003
    s_lshr_b32 s69, s63, 4
    s_lshl_b32 s69, s69, 3
    s_lshl_b32 s82, s86, 0
    s_add_u32 s69, s69, s82
    s_lshl_b32 s86, s68, 4
    s_lshl_b32 s82, s69, 0
    s_add_u32 s86, s86, s82
    s_lshl_b32 s67, s3, 19
    s_lshl_b32 s82, s62, 10
    s_add_u32 s67, s67, s82
    s_lshl_b32 s82, s68, 21
    s_add_u32 s67, s67, s82
    s_lshl_b32 s82, s69, 6
    s_add_u32 s67, s67, s82
    s_mul_i32 s61, s3, 36864
    s_lshl_b32 s60, s64, 24
    s_lshl_b32 s82, s62, 21
    s_add_u32 s60, s60, s82
    s_bfe_u32 s82, s3, 0x10000
    s_lshl_b32 s82, s82, 13
    s_or_b32 s60, s60, s82
    s_bfe_u32 s82, s3, 0x10001
    s_lshl_b32 s82, s82, 20
    s_or_b32 s60, s60, s82
    s_bfe_u32 s82, s65, 0x10000
    s_lshl_b32 s82, s82, 12
    s_or_b32 s60, s60, s82
    s_bfe_u32 s82, s65, 0x10001
    s_lshl_b32 s82, s82, 16
    s_or_b32 s60, s60, s82
    s_bfe_u32 s82, s65, 0x10002
    s_lshl_b32 s82, s82, 19
    s_or_b32 s60, s60, s82
    v_xor_b32 v5, v19, v20
    v_lshlrev_b32 v8, 4, v5
    v_lshl_add_u32 v8, v19, 8, v8
    v_add_u32 v5, 4, v19
    v_xor_b32 v5, v5, v20
    v_lshlrev_b32 v9, 4, v5
    v_lshl_add_u32 v9, v19, 8, v9
    v_add_u32 v5, 8, v19
    v_xor_b32 v5, v5, v20
    v_lshlrev_b32 v10, 4, v5
    v_lshl_add_u32 v10, v19, 8, v10
    v_add_u32 v5, 12, v19
    v_xor_b32 v5, v5, v20
    v_lshlrev_b32 v11, 4, v5
    v_lshl_add_u32 v11, v19, 8, v11
    v_mov_b32 v168, v3
    v_mov_b32 v169, v4
    s_mov_b32 s70, s67
    s_waitcnt lgkmcnt(0)
    s_mov_b32 s44, s4
    s_mov_b32 s45, s5
    s_mov_b32 s46, 0x1000
    s_mov_b32 s47, 0x20000
    buffer_load_dwordx4 v[208:211], v168, s[44:47], 0 offen
    s_load_dwordx2 s[30:31], s[28:29], 0
    s_mov_b32 s48, s10
    s_mov_b32 s49, s11
    s_mov_b32 s50, 0x400000
    s_mov_b32 s51, 0x20000
    s_add_u32 m0, s61, 32768
    s_nop 0
    buffer_load_dwordx4 v169, s[48:51], s70 offen  lds
    s_add_u32 m0, s61, 33792
    s_add_u32 s70, s70, 131072
    buffer_load_dwordx4 v169, s[48:51], s70 offen  lds
    s_add_u32 m0, s61, 34816
    s_add_u32 s70, s70, 131072
    buffer_load_dwordx4 v169, s[48:51], s70 offen  lds
    s_add_u32 m0, s61, 35840
    s_add_u32 s70, s70, 131072
    buffer_load_dwordx4 v169, s[48:51], s70 offen  lds
    s_mov_b32 s32, s6
    s_mov_b32 s33, s7
    s_mov_b32 s34, 0x4000000
    s_mov_b32 s35, 0x20000
    s_add_u32 m0, s61, 0
    s_xor_b32 s66, s60, 0
    buffer_load_dwordx4 v8, s[32:35], s66 offen offset:0 nt lds
    buffer_load_dwordx4 v9, s[32:35], s66 offen offset:1024 nt lds
    buffer_load_dwordx4 v10, s[32:35], s66 offen offset:2048 nt lds
    buffer_load_dwordx4 v11, s[32:35], s66 offen offset:3072 nt lds
    s_add_u32 m0, s61, 4096
    s_xor_b32 s66, s60, 24576
    buffer_load_dwordx4 v8, s[32:35], s66 offen offset:0 nt lds
    s_mov_b32 s40, s28
    s_mov_b32 s41, s29
    s_mov_b32 s42, 0x10000000
    s_mov_b32 s43, 0x20000
    s_mov_b32 s36, s8
    s_mov_b32 s37, s9
    s_mov_b32 s38, 0x4000000
    s_mov_b32 s39, 0x20000
    v_lshlrev_b32 v12, 10, v19
    v_lshl_add_u32 v12, v20, 4, v12
    v_xor_b32 v5, v19, v20
    v_lshl_add_u32 v13, v5, 4, s61
    v_lshl_add_u32 v13, v20, 8, v13
    v_xor_b32 v5, v19, v20
    v_xor_b32 v5, 4, v5
    v_lshl_add_u32 v14, v5, 4, s61
    v_lshl_add_u32 v14, v20, 8, v14
    v_xor_b32 v5, v19, v20
    v_xor_b32 v5, 8, v5
    v_lshl_add_u32 v15, v5, 4, s61
    v_lshl_add_u32 v15, v20, 8, v15
    v_xor_b32 v5, v19, v20
    v_xor_b32 v5, 12, v5
    v_lshl_add_u32 v16, v5, 4, s61
    v_lshl_add_u32 v16, v20, 8, v16
    s_mov_b32 s72, 0x11111111
    s_mov_b32 s73, 0x11111111
    s_mov_b32 s74, 0x22222222
    s_mov_b32 s75, 0x22222222
    s_mov_b32 s76, 0x44444444
    s_mov_b32 s77, 0x44444444
    s_mov_b32 s78, 0x88888888
    s_mov_b32 s79, 0x88888888
    v_mov_b32 v5, 0xffff
    v_mov_b32 v6, 0xffff0000
    v_cndmask_b32 v17, 0, v5, s[72:73]
    v_cndmask_b32 v17, v17, v6, s[74:75]
    v_cndmask_b32 v18, 0, v5, s[76:77]
    v_cndmask_b32 v18, v18, v6, s[78:79]
    s_mul_i32 s67, s3, 1088
    s_add_u32 s67, s67, 147456
    v_add_u32 v176, s67, v2
    v_lshl_add_u32 v177, v19, 9, s61
    v_lshl_add_u32 v177, v22, 6, v177
    v_lshl_add_u32 v177, v21, 3, v177
    s_lshl_b32 s67, s3, 7
    s_lshl_b32 s82, s68, 9
    s_add_u32 s67, s67, s82
    s_add_u32 s67, s67, 147456
    v_lshl_add_u32 v178, v19, 4, s67
    v_mul_u32_u24 v5, 1088, v21
    v_add_u32 v178, v178, v5
    s_lshl_b32 s67, s3, 9
    s_add_u32 s67, s67, 152064
    v_and_b32 v6, 1, v22
    v_lshl_add_u32 v179, v21, 7, s67
    v_lshl_add_u32 v179, v19, 4, v179
    v_lshl_add_u32 v179, v6, 6, v179
    s_lshl_b32 s67, s3, 7
    s_add_u32 s67, s67, 152064
    v_add_u32 v180, s67, v2
    s_waitcnt lgkmcnt(0)
    s_and_b32 s4, s3, 1
    s_lshl_b32 s4, s4, 13
    s_lshl_b32 s5, s2, 1
    s_lshr_b32 s6, s3, 1
    s_add_u32 s5, s5, s6
    s_and_b32 s6, s5, 63
    s_lshl_b32 s6, s6, 7
    s_lshr_b32 s5, s5, 6
    s_lshl_b32 s5, s5, 14
    s_add_u32 s4, s4, s5
    s_add_u32 s4, s4, s6
    s_add_u32 s4, s4, 655360
    s_memtime s[8:9]
    s_waitcnt lgkmcnt(0)
    s_load_dword s7, s[28:29], s4
    s_waitcnt lgkmcnt(0)
    s_memtime s[10:11]
    s_waitcnt lgkmcnt(0)
    s_sub_u32 s10, s10, s8
    v_mov_b32 v181, s10
    s_lshl_b32 s67, s3, 2
    s_add_u32 s67, s67, 163344
    v_mov_b32 v182, s67
    ds_write_b32 v182, v181
    v_mov_b32 v182, 163344
    s_getreg_b32 s67, hwreg(HW_REG_XCC_ID)
    s_and_b32 s67, s67, 15
    s_add_u32 s30, s30, 1
    s_addc_u32 s31, s31, 0
    s_mov_b32 s80, s30
    s_and_b32 s81, s31, 0xfffffff0
    s_or_b32 s81, s81, s67
    s_and_b32 s14, s30, 0xff
    s_and_b32 s15, s30, 0xf
    s_lshl_b32 s67, s67, 5
    s_and_b32 s67, s67, 0xe0
    s_or_b32 s15, s15, s67
    v_mov_b32 v23, 0xffffff00
    s_waitcnt vmcnt(9)
    v_lshlrev_b32 v212, 16, v208
    v_and_b32 v213, 0xffff0000, v208
    v_lshlrev_b32 v214, 16, v209
    v_and_b32 v215, 0xffff0000, v209
    v_lshlrev_b32 v216, 16, v210
    v_and_b32 v217, 0xffff0000, v210
    v_lshlrev_b32 v218, 16, v211
    v_and_b32 v219, 0xffff0000, v211
    v_readfirstlane_b32 s85, v212
    s_nop 1
    v_subrev_f32 v192, s85, v212
    v_subrev_f32 v193, s85, v213
    v_subrev_f32 v194, s85, v214
    v_subrev_f32 v195, s85, v215
    v_subrev_f32 v196, s85, v216
    v_subrev_f32 v197, s85, v217
    v_subrev_f32 v198, s85, v218
    v_subrev_f32 v199, s85, v219
    v_pk_add_f32 v[200:201], v[192:193], v[194:195]
    v_pk_mul_f32 v[202:203], v[192:193], v[192:193]
    v_pk_add_f32 v[204:205], v[196:197], v[198:199]
    v_pk_fma_f32 v[202:203], v[194:195], v[194:195], v[202:203]
    v_pk_add_f32 v[200:201], v[200:201], v[204:205]
    v_pk_fma_f32 v[202:203], v[196:197], v[196:197], v[202:203]
    v_add_f32 v200, v200, v201
    v_pk_fma_f32 v[202:203], v[198:199], v[198:199], v[202:203]
    v_add_f32 v201, v202, v203
    v_add_f32_dpp v200, v200, v200 row_ror:8 row_mask:0xf bank_mask:0xf
    s_nop 0
    v_add_f32_dpp v201, v201, v201 row_ror:8 row_mask:0xf bank_mask:0xf
    v_add_f32_dpp v200, v200, v200 row_ror:4 row_mask:0xf bank_mask:0xf
    s_nop 0
    v_add_f32_dpp v201, v201, v201 row_ror:4 row_mask:0xf bank_mask:0xf
    v_add_f32_dpp v200, v200, v200 row_ror:2 row_mask:0xf bank_mask:0xf
    s_nop 0
    v_add_f32_dpp v201, v201, v201 row_ror:2 row_mask:0xf bank_mask:0xf
    v_add_f32_dpp v200, v200, v200 row_ror:1 row_mask:0xf bank_mask:0xf
    s_nop 0
    v_add_f32_dpp v201, v201, v201 row_ror:1 row_mask:0xf bank_mask:0xf
    v_mov_b32 v204, v200
    v_mov_b32 v205, v201
    s_nop 0
    v_permlane16_swap_b32 v200, v204
    v_permlane16_swap_b32 v201, v205
    v_add_f32 v200, v200, v204
    v_add_f32 v201, v201, v205
    v_mov_b32 v204, v200
    v_mov_b32 v205, v201
    s_nop 0
    v_permlane32_swap_b32 v200, v204
    v_permlane32_swap_b32 v201, v205
    v_add_f32 v200, v200, v204
    v_add_f32 v201, v201, v205
    s_waitcnt vmcnt(7)
    buffer_load_dwordx4 v9, s[32:35], s66 offen offset:1024 nt lds
    s_waitcnt vmcnt(7)
    buffer_load_dwordx4 v10, s[32:35], s66 offen offset:2048 nt lds
    v_mul_f32 v200, 0x3b000000, v200
    v_mul_f32 v201, 0x3b000000, v201
    v_add_f32 v202, s85, v200
    v_fma_f32 v201, -v200, v200, v201
    v_max_f32 v201, 0, v201
    v_cvt_pk_bf16_f32 v200, v202, v201
    v_and_b32 v201, 0xffff0000, v200
    v_lshlrev_b32 v200, 16, v200
    v_add_f32 v201, 0x3727c5ac, v201
    v_sub_f32 v192, v212, v200
    v_sub_f32 v193, v213, v200
    v_sub_f32 v194, v214, v200
    v_sub_f32 v195, v215, v200
    v_cvt_pk_bf16_f32 v201, v201, v201
    v_and_b32 v201, 0xffff0000, v201
    v_sqrt_f32 v201, v201
    v_sub_f32 v196, v216, v200
    v_sub_f32 v197, v217, v200
    v_sub_f32 v198, v218, v200
    v_sub_f32 v199, v219, v200
    v_cvt_pk_bf16_f32 v201, v201, v201
    v_and_b32 v201, 0xffff0000, v201
    v_rcp_f32 v200, v201
    v_cvt_pk_bf16_f32 v208, v192, v193
    v_cvt_pk_bf16_f32 v209, v194, v195
    v_cvt_pk_bf16_f32 v210, v196, v197
    v_cvt_pk_bf16_f32 v211, v198, v199
    v_lshlrev_b32 v192, 16, v208
    v_and_b32 v193, 0xffff0000, v208
    v_lshlrev_b32 v194, 16, v209
    v_and_b32 v195, 0xffff0000, v209
    v_lshlrev_b32 v196, 16, v210
    v_and_b32 v197, 0xffff0000, v210
    v_lshlrev_b32 v198, 16, v211
    v_and_b32 v199, 0xffff0000, v211
    v_pk_mul_f32 v[192:193], v[192:193], v[200:201] op_sel_hi:[1,0]
    v_pk_mul_f32 v[194:195], v[194:195], v[200:201] op_sel_hi:[1,0]
    v_pk_mul_f32 v[196:197], v[196:197], v[200:201] op_sel_hi:[1,0]
    v_pk_mul_f32 v[198:199], v[198:199], v[200:201] op_sel_hi:[1,0]
    v_cvt_pk_bf16_f32 v208, v192, v193
    v_cvt_pk_bf16_f32 v209, v194, v195
    v_cvt_pk_bf16_f32 v210, v196, v197
    v_cvt_pk_bf16_f32 v211, v198, v199
    ds_write_b128 v176, v[208:211]
    s_waitcnt vmcnt(7)
    buffer_load_dwordx4 v11, s[32:35], s66 offen offset:3072 nt lds
    s_add_u32 m0, s61, 8192
    s_xor_b32 s66, s60, 32768
    s_waitcnt vmcnt(7)
    buffer_load_dwordx4 v8, s[32:35], s66 offen offset:0 nt lds
    ds_read_b64_tr_b16 v[96:97], v177 offset:32768
    ds_read_b64_tr_b16 v[98:99], v177 offset:33024
    ds_read_b64_tr_b16 v[100:101], v177 offset:34816
    ds_read_b64_tr_b16 v[102:103], v177 offset:35072
    ds_read_b64_tr_b16 v[104:105], v177 offset:32800
    ds_read_b64_tr_b16 v[106:107], v177 offset:33056
    ds_read_b64_tr_b16 v[108:109], v177 offset:34848
    ds_read_b64_tr_b16 v[110:111], v177 offset:35104
    s_waitcnt vmcnt(7)
    buffer_load_dwordx4 v9, s[32:35], s66 offen offset:1024 nt lds
    s_waitcnt vmcnt(7)
    buffer_load_dwordx4 v10, s[32:35], s66 offen offset:2048 nt lds
    s_waitcnt lgkmcnt(0)
    s_barrier
    ds_read_b128 v[184:187], v182
    ds_read_b128 v[112:115], v178 offset:0
    ds_read_b128 v[116:119], v178 offset:64
    s_waitcnt vmcnt(7)
    buffer_load_dwordx4 v11, s[32:35], s66 offen offset:3072 nt lds
    s_mov_b32 vcc_lo, 0xf0f0f0f0
    s_mov_b32 vcc_hi, 0xf0f0f0f0
    s_waitcnt lgkmcnt(1)
    v_mfma_f32_16x16x32_bf16 v[24:27], v[96:99], v[112:115], 0
    v_mfma_f32_16x16x32_bf16 v[28:31], v[104:107], v[112:115], 0
    s_waitcnt lgkmcnt(0)
    v_mfma_f32_16x16x32_bf16 v[24:27], v[100:103], v[116:119], v[24:27]
    v_mfma_f32_16x16x32_bf16 v[28:31], v[108:111], v[116:119], v[28:31]
    s_nop 7
    v_cndmask_b32 v24, v24, v28, vcc
    v_cndmask_b32 v25, v25, v29, vcc
    v_cndmask_b32 v26, v26, v30, vcc
    v_cndmask_b32 v27, v27, v31, vcc
    s_mov_b32 exec_lo, 0x00ff00ff
    s_mov_b32 exec_hi, 0x00ff00ff
    ds_write_b128 v179, v[24:27]
    s_mov_b64 exec, -1
    s_add_u32 m0, s61, 12288
    s_xor_b32 s66, s60, 57344
    s_waitcnt vmcnt(7)
    buffer_load_dwordx4 v8, s[32:35], s66 offen offset:0 nt lds
    s_waitcnt lgkmcnt(0)
    s_barrier
    ds_read_b128 v[96:99], v180 offset:0
    ds_read_b128 v[100:103], v180 offset:512
    ds_read_b128 v[104:107], v180 offset:1024
    ds_read_b128 v[108:111], v180 offset:1536
    s_lshl_b32 s67, s62, 14
    s_lshl_b32 s82, s3, 12
    s_add_u32 s67, s67, s82
    s_lshl_b32 s82, s86, 7
    s_add_u32 s67, s67, s82
    s_add_u32 s67, s67, 786432
    s_waitcnt lgkmcnt(2)
    v_pk_add_f32 v[96:97], v[96:97], v[100:101]
    v_pk_add_f32 v[98:99], v[98:99], v[102:103]
    s_waitcnt lgkmcnt(0)
    v_pk_add_f32 v[104:105], v[104:105], v[108:109]
    v_pk_add_f32 v[106:107], v[106:107], v[110:111]
    v_pk_add_f32 v[96:97], v[96:97], v[104:105]
    v_pk_add_f32 v[98:99], v[98:99], v[106:107]
    v_add_u32 v96, 0x80, v96
    v_add_u32 v97, 0x80, v97
    v_add_u32 v98, 0x80, v98
    v_add_u32 v99, 0x80, v99
    v_and_or_b32 v168, v96, v23, s14
    v_and_or_b32 v169, v97, v23, s14
    v_and_or_b32 v170, v98, v23, s14
    v_and_or_b32 v171, v99, v23, s15
    v_add_u32 v184, v184, v186
    v_add_u32 v185, v185, v187
    v_cmp_gt_u32 vcc, v184, v185
    s_nop 1
    v_cndmask_b32 v184, 0, 16, vcc
    v_or_b32 v171, v171, v184
    s_mov_b64 exec, 0xff
    buffer_store_dwordx4 v[168:171], v2, s[40:43], s67 offen sc1
    s_mov_b64 exec, -1
    s_waitcnt vmcnt(8)
    buffer_load_dwordx4 v9, s[32:35], s66 offen offset:1024 nt lds
    s_waitcnt vmcnt(8)
    buffer_load_dwordx4 v10, s[32:35], s66 offen offset:2048 nt lds
    s_waitcnt vmcnt(8)
    buffer_load_dwordx4 v11, s[32:35], s66 offen offset:3072 nt lds
    s_add_u32 m0, s61, 16384
    s_xor_b32 s66, s60, 131072
    s_waitcnt vmcnt(8)
    buffer_load_dwordx4 v8, s[32:35], s66 offen offset:0 nt lds
    s_waitcnt vmcnt(8)
    buffer_load_dwordx4 v9, s[32:35], s66 offen offset:1024 nt lds
    s_waitcnt vmcnt(8)
    buffer_load_dwordx4 v10, s[32:35], s66 offen offset:2048 nt lds
    s_waitcnt vmcnt(8)
    buffer_load_dwordx4 v11, s[32:35], s66 offen offset:3072 nt lds
    s_add_u32 m0, s61, 20480
    s_xor_b32 s66, s60, 155648
    s_waitcnt vmcnt(8)
    buffer_load_dwordx4 v8, s[32:35], s66 offen offset:0 nt lds
    s_waitcnt vmcnt(7)
    buffer_load_dwordx4 v9, s[32:35], s66 offen offset:1024 nt lds
    s_waitcnt vmcnt(7)
    buffer_load_dwordx4 v10, s[32:35], s66 offen offset:2048 nt lds
    s_waitcnt vmcnt(7)
    buffer_load_dwordx4 v11, s[32:35], s66 offen offset:3072 nt lds
    s_add_u32 m0, s61, 24576
    s_xor_b32 s66, s60, 163840
    s_waitcnt vmcnt(7)
    buffer_load_dwordx4 v8, s[32:35], s66 offen offset:0 nt lds
    s_waitcnt vmcnt(7)
    buffer_load_dwordx4 v9, s[32:35], s66 offen offset:1024 nt lds
    s_waitcnt vmcnt(7)
    buffer_load_dwordx4 v10, s[32:35], s66 offen offset:2048 nt lds
    s_waitcnt vmcnt(7)
    buffer_load_dwordx4 v11, s[32:35], s66 offen offset:3072 nt lds
    s_add_u32 m0, s61, 28672
    s_xor_b32 s66, s60, 188416
    s_waitcnt vmcnt(7)
    buffer_load_dwordx4 v8, s[32:35], s66 offen offset:0 nt lds
    s_waitcnt vmcnt(7)
    buffer_load_dwordx4 v9, s[32:35], s66 offen offset:1024 nt lds
    s_waitcnt vmcnt(7)
    buffer_load_dwordx4 v10, s[32:35], s66 offen offset:2048 nt lds
    s_waitcnt vmcnt(7)
    buffer_load_dwordx4 v11, s[32:35], s66 offen offset:3072 nt lds
    s_add_u32 m0, s61, 32768
    s_xor_b32 s66, s60, 262144
    s_waitcnt vmcnt(7)
    buffer_load_dwordx4 v8, s[32:35], s66 offen offset:0 nt lds
    s_waitcnt vmcnt(7)
    buffer_load_dwordx4 v9, s[32:35], s66 offen offset:1024 nt lds
    s_waitcnt vmcnt(7)
    buffer_load_dwordx4 v10, s[32:35], s66 offen offset:2048 nt lds
    s_waitcnt vmcnt(7)
    buffer_load_dwordx4 v11, s[32:35], s66 offen offset:3072 nt lds
    s_xor_b32 s66, s60, 0
    s_waitcnt vmcnt(7)
    buffer_load_dwordx4 a[0:3], v12, s[36:39], s66 offen offset:0 nt
    s_waitcnt vmcnt(7)
    buffer_load_dwordx4 a[4:7], v12, s[36:39], s66 offen offset:256 nt
    s_waitcnt vmcnt(7)
    buffer_load_dwordx4 a[8:11], v12, s[36:39], s66 offen offset:512 nt
    s_waitcnt vmcnt(7)
    buffer_load_dwordx4 a[12:15], v12, s[36:39], s66 offen offset:768 nt
    s_xor_b32 s66, s60, 24576
    s_waitcnt vmcnt(7)
    buffer_load_dwordx4 a[16:19], v12, s[36:39], s66 offen offset:0 nt
    s_waitcnt vmcnt(7)
    buffer_load_dwordx4 a[20:23], v12, s[36:39], s66 offen offset:256 nt
    s_waitcnt vmcnt(7)
    buffer_load_dwordx4 a[24:27], v12, s[36:39], s66 offen offset:512 nt
    s_waitcnt vmcnt(7)
    buffer_load_dwordx4 a[28:31], v12, s[36:39], s66 offen offset:768 nt
    s_xor_b32 s66, s60, 32768
    s_waitcnt vmcnt(7)
    buffer_load_dwordx4 a[32:35], v12, s[36:39], s66 offen offset:0 nt
    s_waitcnt vmcnt(7)
    buffer_load_dwordx4 a[36:39], v12, s[36:39], s66 offen offset:256 nt
    s_waitcnt vmcnt(7)
    buffer_load_dwordx4 a[40:43], v12, s[36:39], s66 offen offset:512 nt
    s_waitcnt vmcnt(7)
    buffer_load_dwordx4 a[44:47], v12, s[36:39], s66 offen offset:768 nt
    s_xor_b32 s66, s60, 57344
    s_waitcnt vmcnt(7)
    buffer_load_dwordx4 a[48:51], v12, s[36:39], s66 offen offset:0 nt
    s_waitcnt vmcnt(7)
    buffer_load_dwordx4 a[52:55], v12, s[36:39], s66 offen offset:256 nt
    s_waitcnt vmcnt(7)
    buffer_load_dwordx4 a[56:59], v12, s[36:39], s66 offen offset:512 nt
    s_waitcnt vmcnt(7)
    buffer_load_dwordx4 a[60:63], v12, s[36:39], s66 offen offset:768 nt
    s_xor_b32 s66, s60, 131072
    s_waitcnt vmcnt(7)
    buffer_load_dwordx4 a[64:67], v12, s[36:39], s66 offen offset:0 nt
    s_waitcnt vmcnt(7)
    buffer_load_dwordx4 a[68:71], v12, s[36:39], s66 offen offset:256 nt
    v_lshrrev_b32 v3, 5, v1
    v_and_b32 v4, 31, v1
    v_lshlrev_b32 v172, 11, v3
    v_lshl_add_u32 v172, v4, 4, v172
    s_lshl_b32 s70, s62, 14
    s_lshl_b32 s82, s64, 12
    s_add_u32 s70, s70, s82
    s_lshl_b32 s82, s3, 9
    s_add_u32 s70, s70, s82
    s_add_u32 s70, s70, 786432
    buffer_load_dwordx4 v[168:171], v172, s[40:43], s70 offen sc1
    s_waitcnt vmcnt(8)
    buffer_load_dwordx4 a[72:75], v12, s[36:39], s66 offen offset:512 nt
    s_waitcnt vmcnt(8)
    buffer_load_dwordx4 a[76:79], v12, s[36:39], s66 offen offset:768 nt
    s_xor_b32 s66, s60, 155648
    s_waitcnt vmcnt(8)
    buffer_load_dwordx4 a[80:83], v12, s[36:39], s66 offen offset:0 nt
    s_waitcnt vmcnt(8)
    buffer_load_dwordx4 a[84:87], v12, s[36:39], s66 offen offset:256 nt
    s_waitcnt vmcnt(8)
    buffer_load_dwordx4 a[88:91], v12, s[36:39], s66 offen offset:512 nt
    s_waitcnt vmcnt(8)
    buffer_load_dwordx4 a[92:95], v12, s[36:39], s66 offen offset:768 nt
    s_xor_b32 s66, s60, 163840
    s_waitcnt vmcnt(8)
    buffer_load_dwordx4 a[96:99], v12, s[36:39], s66 offen offset:0 nt
    s_waitcnt vmcnt(8)
    buffer_load_dwordx4 a[100:103], v12, s[36:39], s66 offen offset:256 nt
    s_waitcnt vmcnt(8)
    s_mov_b32 s84, 0
L_QCHK:
    v_xor_b32 v5, s15, v171
    v_and_b32 v3, 0xf, v5
    v_xor_b32 v168, s14, v168
    v_xor_b32 v169, s14, v169
    v_xor_b32 v170, s14, v170
    v_or3_b32 v3, v3, v168, v169
    v_or_b32 v3, v3, v170
    v_and_b32 v3, 0xff, v3
    v_cmp_ne_u32 vcc, 0, v3
    s_cbranch_vccnz L_QRETRY
L_QOK:
    v_and_b32 v171, v23, v171
    v_and_b32 v5, 0xf0, v5
    v_mov_b32 v96, v168
    v_mov_b32 v97, v169
    v_mov_b32 v98, v170
    v_mov_b32 v99, v171
    v_permlane32_swap_b32 v168, v96
    v_permlane32_swap_b32 v169, v97
    v_permlane32_swap_b32 v170, v98
    v_permlane32_swap_b32 v171, v99
    v_add_f32 v168, v168, v96
    v_add_f32 v169, v169, v97
    v_add_f32 v170, v170, v98
    v_add_f32 v171, v171, v99
    s_lshl_b32 s67, s3, 8
    s_add_u32 s67, s67, 161280
    v_lshl_add_u32 v3, v1, 2, s67
    v_and_b32 v4, 31, v1
    v_lshl_add_u32 v7, v4, 3, s67
    v_cvt_pk_bf16_f32 v168, v168, v169
    v_cvt_pk_bf16_f32 v169, v170, v171
    ds_write_b64 v7, v[168:169]
    ds_write_b32 v3, v5 offset:1024
    v_lshlrev_b32 v4, 8, v22
    v_lshl_add_u32 v4, v19, 4, v4
    v_add_u32 v4, 161280, v4
    v_add_u32 v6, 162304, v2
    s_waitcnt vmcnt(7)
    buffer_load_dwordx4 a[104:107], v12, s[36:39], s66 offen offset:512 nt
    s_waitcnt lgkmcnt(0)
    s_barrier
    ds_read_b128 v[168:171], v6
    ds_read_b128 v[176:179], v4 offset:0
    ds_read_b128 v[180:183], v4 offset:64
    ds_read_b128 v[184:187], v4 offset:128
    ds_read_b128 v[188:191], v4 offset:192
    ds_read_b128 v[96:99], v13 offset:0
    ds_read_b128 v[100:103], v14 offset:0
    ds_read_b128 v[104:107], v15 offset:0
    ds_read_b128 v[108:111], v16 offset:0
    s_waitcnt vmcnt(7)
    buffer_load_dwordx4 a[108:111], v12, s[36:39], s66 offen offset:768 nt
    s_waitcnt lgkmcnt(4)
    v_or3_b32 v3, v168, v169, v170
    v_or_b32 v3, v3, v171
    s_mov_b32 s87, 0
    v_and_b32 v4, 16, v168
    v_cmp_ne_u32 vcc, 0, v4
    s_nop 0
    s_bcnt1_i32_b64 s67, vcc
    s_add_u32 s87, s87, s67
    v_and_b32 v4, 16, v169
    v_cmp_ne_u32 vcc, 0, v4
    s_nop 0
    s_bcnt1_i32_b64 s67, vcc
    s_add_u32 s87, s87, s67
    v_and_b32 v4, 16, v170
    v_cmp_ne_u32 vcc, 0, v4
    s_nop 0
    s_bcnt1_i32_b64 s67, vcc
    s_add_u32 s87, s87, s67
    v_and_b32 v4, 16, v171
    v_cmp_ne_u32 vcc, 0, v4
    s_nop 0
    s_bcnt1_i32_b64 s67, vcc
    s_add_u32 s87, s87, s67
    s_cmp_gt_u32 s87, 128
    s_cselect_b32 s87, 8192, 0
    v_and_b32 v3, 0xe0, v3
    v_cmp_ne_u32 vcc, 0, v3
    s_nop 0
    s_cmp_eq_u64 vcc, 0
    s_cselect_b32 s83, 1, 0
    v_mov_b32 v200, -1
    v_mov_b32 v201, -1
    v_mov_b32 v202, -1
    v_mov_b32 v203, -1
    s_lshl_b32 s67, s62, 15
    s_lshl_b32 s82, s65, 12
    s_add_u32 s67, s67, s82
    s_lshl_b32 s82, s3, 10
    s_add_u32 s67, s67, s82
    s_lshl_b32 s82, s64, 4
    s_add_u32 s67, s67, s82
    s_add_u32 s67, s67, 262144
    v_lshlrev_b32 v3, 6, v1
    s_mov_b64 exec, 0xffff
    s_cmp_eq_u32 s83, 0
    s_cbranch_scc1 SLOW_1
    buffer_store_dwordx4 v[200:203], v3, s[40:43], s67 offen
BACK_2:
    s_mov_b64 exec, -1
    v_cndmask_b32 v32, 0, v176, s[72:73]
    v_cndmask_b32 v33, 0, v177, s[72:73]
    v_cndmask_b32 v34, 0, v178, s[72:73]
    v_cndmask_b32 v35, 0, v179, s[72:73]
    v_cndmask_b32 v36, 0, v180, s[72:73]
    v_cndmask_b32 v37, 0, v181, s[72:73]
    v_cndmask_b32 v38, 0, v182, s[72:73]
    v_cndmask_b32 v39, 0, v183, s[72:73]
    v_cndmask_b32 v40, 0, v184, s[72:73]
    v_cndmask_b32 v41, 0, v185, s[72:73]
    v_cndmask_b32 v42, 0, v186, s[72:73]
    v_cndmask_b32 v43, 0, v187, s[72:73]
    v_cndmask_b32 v44, 0, v188, s[72:73]
    v_cndmask_b32 v45, 0, v189, s[72:73]
    v_cndmask_b32 v46, 0, v190, s[72:73]
    v_cndmask_b32 v47, 0, v191, s[72:73]
    ds_read_b128 v[112:115], v13 offset:4096
    ds_read_b128 v[116:119], v14 offset:4096
    ds_read_b128 v[120:123], v15 offset:4096
    ds_read_b128 v[124:127], v16 offset:4096
    s_waitcnt lgkmcnt(7)
    v_mfma_f32_16x16x32_bf16 v[128:131], v[96:99], v[32:35], 0
    s_waitcnt lgkmcnt(6)
    v_mfma_f32_16x16x32_bf16 v[128:131], v[100:103], v[36:39], v[128:131]
    s_waitcnt lgkmcnt(5)
    v_mfma_f32_16x16x32_bf16 v[128:131], v[104:107], v[40:43], v[128:131]
    s_waitcnt lgkmcnt(4)
    v_mfma_f32_16x16x32_bf16 v[128:131], v[108:111], v[44:47], v[128:131]
    v_cndmask_b32 v48, 0, v176, s[74:75]
    v_cndmask_b32 v49, 0, v177, s[74:75]
    v_cndmask_b32 v50, 0, v178, s[74:75]
    v_cndmask_b32 v51, 0, v179, s[74:75]
    v_cndmask_b32 v52, 0, v180, s[74:75]
    v_cndmask_b32 v53, 0, v181, s[74:75]
    v_cndmask_b32 v54, 0, v182, s[74:75]
    v_cndmask_b32 v55, 0, v183, s[74:75]
    v_cndmask_b32 v56, 0, v184, s[74:75]
    v_cndmask_b32 v57, 0, v185, s[74:75]
    v_cndmask_b32 v58, 0, v186, s[74:75]
    v_cndmask_b32 v59, 0, v187, s[74:75]
    v_cndmask_b32 v60, 0, v188, s[74:75]
    v_cndmask_b32 v61, 0, v189, s[74:75]
    v_cndmask_b32 v62, 0, v190, s[74:75]
    v_cndmask_b32 v63, 0, v191, s[74:75]
    s_xor_b32 s66, s60, 188416
    s_waitcnt vmcnt(8)
    buffer_load_dwordx4 a[112:115], v12, s[36:39], s66 offen offset:0 nt
    v_cndmask_b32 v64, 0, v176, s[76:77]
    v_cndmask_b32 v65, 0, v177, s[76:77]
    v_cndmask_b32 v66, 0, v178, s[76:77]
    v_cndmask_b32 v67, 0, v179, s[76:77]
    v_cndmask_b32 v68, 0, v180, s[76:77]
    v_cndmask_b32 v69, 0, v181, s[76:77]
    v_cndmask_b32 v70, 0, v182, s[76:77]
    v_cndmask_b32 v71, 0, v183, s[76:77]
    v_cndmask_b32 v72, 0, v184, s[76:77]
    v_cndmask_b32 v73, 0, v185, s[76:77]
    v_cndmask_b32 v74, 0, v186, s[76:77]
    v_cndmask_b32 v75, 0, v187, s[76:77]
    v_cndmask_b32 v76, 0, v188, s[76:77]
    v_cndmask_b32 v77, 0, v189, s[76:77]
    v_cndmask_b32 v78, 0, v190, s[76:77]
    v_cndmask_b32 v79, 0, v191, s[76:77]
    v_cndmask_b32 v80, 0, v176, s[78:79]
    v_cndmask_b32 v81, 0, v177, s[78:79]
    v_cndmask_b32 v82, 0, v178, s[78:79]
    v_cndmask_b32 v83, 0, v179, s[78:79]
    v_cndmask_b32 v84, 0, v180, s[78:79]
    v_cndmask_b32 v85, 0, v181, s[78:79]
    v_cndmask_b32 v86, 0, v182, s[78:79]
    v_cndmask_b32 v87, 0, v183, s[78:79]
    v_cndmask_b32 v88, 0, v184, s[78:79]
    v_cndmask_b32 v89, 0, v185, s[78:79]
    v_cndmask_b32 v90, 0, v186, s[78:79]
    v_cndmask_b32 v91, 0, v187, s[78:79]
    v_cndmask_b32 v92, 0, v188, s[78:79]
    v_cndmask_b32 v93, 0, v189, s[78:79]
    v_cndmask_b32 v94, 0, v190, s[78:79]
    v_cndmask_b32 v95, 0, v191, s[78:79]
    s_waitcnt vmcnt(8)
    buffer_load_dwordx4 a[116:119], v12, s[36:39], s66 offen offset:256 nt
    s_waitcnt vmcnt(8)
    buffer_load_dwordx4 a[120:123], v12, s[36:39], s66 offen offset:512 nt
    s_waitcnt vmcnt(8)
    buffer_load_dwordx4 a[124:127], v12, s[36:39], s66 offen offset:768 nt
    ds_read_b128 v[96:99], v13 offset:8192
    ds_read_b128 v[100:103], v14 offset:8192
    ds_read_b128 v[104:107], v15 offset:8192
    ds_read_b128 v[108:111], v16 offset:8192
    s_waitcnt lgkmcnt(7)
    v_mfma_f32_16x16x32_bf16 v[128:131], v[112:115], v[48:51], v[128:131]
    s_waitcnt lgkmcnt(6)
    v_mfma_f32_16x16x32_bf16 v[128:131], v[116:119], v[52:55], v[128:131]
    s_waitcnt lgkmcnt(5)
    v_mfma_f32_16x16x32_bf16 v[128:131], v[120:123], v[56:59], v[128:131]
    s_waitcnt lgkmcnt(4)
    v_mfma_f32_16x16x32_bf16 v[128:131], v[124:127], v[60:63], v[128:131]
    s_add_u32 m0, s61, 0
    s_xor_b32 s66, s60, 286720
    s_waitcnt vmcnt(8)
    buffer_load_dwordx4 v8, s[32:35], s66 offen offset:0 nt lds
    s_waitcnt vmcnt(8)
    buffer_load_dwordx4 v9, s[32:35], s66 offen offset:1024 nt lds
    ds_read_b128 v[112:115], v13 offset:12288
    ds_read_b128 v[116:119], v14 offset:12288
    ds_read_b128 v[120:123], v15 offset:12288
    ds_read_b128 v[124:127], v16 offset:12288
    s_waitcnt lgkmcnt(7)
    v_mfma_f32_16x16x32_bf16 v[128:131], v[96:99], v[64:67], v[128:131]
    s_waitcnt lgkmcnt(6)
    v_mfma_f32_16x16x32_bf16 v[128:131], v[100:103], v[68:71], v[128:131]
    s_waitcnt lgkmcnt(5)
    v_mfma_f32_16x16x32_bf16 v[128:131], v[104:107], v[72:75], v[128:131]
    s_waitcnt lgkmcnt(4)
    v_mfma_f32_16x16x32_bf16 v[128:131], v[108:111], v[76:79], v[128:131]
    s_waitcnt vmcnt(8)
    buffer_load_dwordx4 v10, s[32:35], s66 offen offset:2048 nt lds
    s_waitcnt vmcnt(8)
    buffer_load_dwordx4 v11, s[32:35], s66 offen offset:3072 nt lds
    ds_read_b128 v[96:99], v13 offset:16384
    ds_read_b128 v[100:103], v14 offset:16384
    ds_read_b128 v[104:107], v15 offset:16384
    ds_read_b128 v[108:111], v16 offset:16384
    s_waitcnt lgkmcnt(7)
    v_mfma_f32_16x16x32_bf16 v[128:131], v[112:115], v[80:83], v[128:131]
    s_waitcnt lgkmcnt(6)
    v_mfma_f32_16x16x32_bf16 v[128:131], v[116:119], v[84:87], v[128:131]
    s_waitcnt lgkmcnt(5)
    v_mfma_f32_16x16x32_bf16 v[128:131], v[120:123], v[88:91], v[128:131]
    s_waitcnt lgkmcnt(4)
    v_mfma_f32_16x16x32_bf16 v[128:131], v[124:127], v[92:95], v[128:131]
    s_nop 7
    v_cvt_pk_bf16_f32 v3, v128, v129
    v_cvt_pk_bf16_f32 v4, v130, v131
    v_lshlrev_b32 v128, 16, v3
    v_and_b32 v129, 0xffff0000, v3
    v_lshlrev_b32 v130, 16, v4
    v_and_b32 v131, 0xffff0000, v4
    v_mul_f32 v128, 0x3db504f3, v128
    v_mul_f32 v129, 0x3db504f3, v129
    v_mul_f32 v130, 0x3db504f3, v130
    v_mul_f32 v131, 0x3db504f3, v131
    v_cvt_pk_bf16_f32 v3, v128, v129
    v_cvt_pk_bf16_f32 v4, v130, v131
    v_lshlrev_b32 v128, 16, v3
    v_and_b32 v129, 0xffff0000, v3
    v_lshlrev_b32 v130, 16, v4
    v_and_b32 v131, 0xffff0000, v4
    s_add_u32 m0, s61, 4096
    s_xor_b32 s66, s60, 294912
    s_waitcnt vmcnt(7)
    buffer_load_dwordx4 v8, s[32:35], s66 offen offset:0 nt lds
    s_waitcnt vmcnt(7)
    buffer_load_dwordx4 v9, s[32:35], s66 offen offset:1024 nt lds
    ds_read_b128 v[112:115], v13 offset:20480
    ds_read_b128 v[116:119], v14 offset:20480
    ds_read_b128 v[120:123], v15 offset:20480
    ds_read_b128 v[124:127], v16 offset:20480
    s_waitcnt lgkmcnt(7)
    v_mfma_f32_16x16x32_bf16 v[132:135], v[96:99], v[32:35], 0
    s_waitcnt lgkmcnt(6)
    v_mfma_f32_16x16x32_bf16 v[132:135], v[100:103], v[36:39], v[132:135]
    s_waitcnt lgkmcnt(5)
    v_mfma_f32_16x16x32_bf16 v[132:135], v[104:107], v[40:43], v[132:135]
    s_waitcnt lgkmcnt(4)
    v_mfma_f32_16x16x32_bf16 v[132:135], v[108:111], v[44:47], v[132:135]
    s_waitcnt vmcnt(7)
    buffer_load_dwordx4 v10, s[32:35], s66 offen offset:2048 nt lds
    s_waitcnt vmcnt(7)
    buffer_load_dwordx4 v11, s[32:35], s66 offen offset:3072 nt lds
    ds_read_b128 v[96:99], v13 offset:24576
    ds_read_b128 v[100:103], v14 offset:24576
    ds_read_b128 v[104:107], v15 offset:24576
    ds_read_b128 v[108:111], v16 offset:24576
    s_waitcnt lgkmcnt(7)
    v_mfma_f32_16x16x32_bf16 v[132:135], v[112:115], v[48:51], v[132:135]
    s_waitcnt lgkmcnt(6)
    v_mfma_f32_16x16x32_bf16 v[132:135], v[116:119], v[52:55], v[132:135]
    s_waitcnt lgkmcnt(5)
    v_mfma_f32_16x16x32_bf16 v[132:135], v[120:123], v[56:59], v[132:135]
    s_waitcnt lgkmcnt(4)
    v_mfma_f32_16x16x32_bf16 v[132:135], v[124:127], v[60:63], v[132:135]
    s_add_u32 m0, s61, 8192
    s_xor_b32 s66, s60, 319488
    s_waitcnt vmcnt(7)
    buffer_load_dwordx4 v8, s[32:35], s66 offen offset:0 nt lds
    s_waitcnt vmcnt(7)
    buffer_load_dwordx4 v9, s[32:35], s66 offen offset:1024 nt lds
    ds_read_b128 v[112:115], v13 offset:28672
    ds_read_b128 v[116:119], v14 offset:28672
    ds_read_b128 v[120:123], v15 offset:28672
    ds_read_b128 v[124:127], v16 offset:28672
    s_waitcnt lgkmcnt(7)
    v_mfma_f32_16x16x32_bf16 v[132:135], v[96:99], v[64:67], v[132:135]
    s_waitcnt lgkmcnt(6)
    v_mfma_f32_16x16x32_bf16 v[132:135], v[100:103], v[68:71], v[132:135]
    s_waitcnt lgkmcnt(5)
    v_mfma_f32_16x16x32_bf16 v[132:135], v[104:107], v[72:75], v[132:135]
    s_waitcnt lgkmcnt(4)
    v_mfma_f32_16x16x32_bf16 v[132:135], v[108:111], v[76:79], v[132:135]
    s_waitcnt vmcnt(7)
    buffer_load_dwordx4 v10, s[32:35], s66 offen offset:2048 nt lds
    s_waitcnt vmcnt(7)
    buffer_load_dwordx4 v11, s[32:35], s66 offen offset:3072 nt lds
    ds_read_b128 v[96:99], v13 offset:32768
    ds_read_b128 v[100:103], v14 offset:32768
    ds_read_b128 v[104:107], v15 offset:32768
    ds_read_b128 v[108:111], v16 offset:32768
    s_waitcnt lgkmcnt(7)
    v_mfma_f32_16x16x32_bf16 v[132:135], v[112:115], v[80:83], v[132:135]
    s_waitcnt lgkmcnt(6)
    v_mfma_f32_16x16x32_bf16 v[132:135], v[116:119], v[84:87], v[132:135]
    s_waitcnt lgkmcnt(5)
    v_mfma_f32_16x16x32_bf16 v[132:135], v[120:123], v[88:91], v[132:135]
    s_waitcnt lgkmcnt(4)
    v_mfma_f32_16x16x32_bf16 v[132:135], v[124:127], v[92:95], v[132:135]
    s_nop 7
    v_cvt_pk_bf16_f32 v3, v132, v133
    v_cvt_pk_bf16_f32 v4, v134, v135
    v_lshlrev_b32 v132, 16, v3
    v_and_b32 v133, 0xffff0000, v3
    v_lshlrev_b32 v134, 16, v4
    v_and_b32 v135, 0xffff0000, v4
    v_mul_f32 v132, 0x3db504f3, v132
    v_mul_f32 v133, 0x3db504f3, v133
    v_mul_f32 v134, 0x3db504f3, v134
    v_mul_f32 v135, 0x3db504f3, v135
    v_cvt_pk_bf16_f32 v3, v132, v133
    v_cvt_pk_bf16_f32 v4, v134, v135
    v_lshlrev_b32 v132, 16, v3
    v_and_b32 v133, 0xffff0000, v3
    v_lshlrev_b32 v134, 16, v4
    v_and_b32 v135, 0xffff0000, v4
    s_add_u32 m0, s61, 12288
    s_xor_b32 s66, s60, 393216
    s_waitcnt vmcnt(7)
    buffer_load_dwordx4 v8, s[32:35], s66 offen offset:0 nt lds
    s_waitcnt vmcnt(7)
    buffer_load_dwordx4 v9, s[32:35], s66 offen offset:1024 nt lds
    s_waitcnt lgkmcnt(3)
    v_mfma_f32_16x16x32_bf16 v[136:139], v[96:99], v[32:35], 0
    s_waitcnt lgkmcnt(2)
    v_mfma_f32_16x16x32_bf16 v[136:139], v[100:103], v[36:39], v[136:139]
    s_waitcnt lgkmcnt(1)
    v_mfma_f32_16x16x32_bf16 v[136:139], v[104:107], v[40:43], v[136:139]
    s_waitcnt lgkmcnt(0)
    v_mfma_f32_16x16x32_bf16 v[136:139], v[108:111], v[44:47], v[136:139]
    s_waitcnt vmcnt(7)
    buffer_load_dwordx4 v10, s[32:35], s66 offen offset:2048 nt lds
    s_waitcnt vmcnt(7)
    buffer_load_dwordx4 v11, s[32:35], s66 offen offset:3072 nt lds
    s_add_u32 m0, s61, 16384
    s_xor_b32 s66, s60, 417792
    s_waitcnt vmcnt(7)
    buffer_load_dwordx4 v8, s[32:35], s66 offen offset:0 nt lds
    ds_read_b128 v[112:115], v13 offset:0
    ds_read_b128 v[116:119], v14 offset:0
    ds_read_b128 v[120:123], v15 offset:0
    ds_read_b128 v[124:127], v16 offset:0
    s_waitcnt lgkmcnt(3)
    v_mfma_f32_16x16x32_bf16 v[136:139], v[112:115], v[48:51], v[136:139]
    s_waitcnt lgkmcnt(2)
    v_mfma_f32_16x16x32_bf16 v[136:139], v[116:119], v[52:55], v[136:139]
    s_waitcnt lgkmcnt(1)
    v_mfma_f32_16x16x32_bf16 v[136:139], v[120:123], v[56:59], v[136:139]
    s_waitcnt lgkmcnt(0)
    v_mfma_f32_16x16x32_bf16 v[136:139], v[124:127], v[60:63], v[136:139]
    s_waitcnt vmcnt(7)
    buffer_load_dwordx4 v9, s[32:35], s66 offen offset:1024 nt lds
    ds_read_b128 v[96:99], v13 offset:4096
    ds_read_b128 v[100:103], v14 offset:4096
    ds_read_b128 v[104:107], v15 offset:4096
    ds_read_b128 v[108:111], v16 offset:4096
    s_waitcnt lgkmcnt(3)
    v_mfma_f32_16x16x32_bf16 v[136:139], v[96:99], v[64:67], v[136:139]
    s_waitcnt lgkmcnt(2)
    v_mfma_f32_16x16x32_bf16 v[136:139], v[100:103], v[68:71], v[136:139]
    s_waitcnt lgkmcnt(1)
    v_mfma_f32_16x16x32_bf16 v[136:139], v[104:107], v[72:75], v[136:139]
    s_waitcnt lgkmcnt(0)
    v_mfma_f32_16x16x32_bf16 v[136:139], v[108:111], v[76:79], v[136:139]
    s_waitcnt vmcnt(7)
    buffer_load_dwordx4 v10, s[32:35], s66 offen offset:2048 nt lds
    s_waitcnt vmcnt(7)
    buffer_load_dwordx4 v11, s[32:35], s66 offen offset:3072 nt lds
    ds_read_b128 v[112:115], v13 offset:8192
    ds_read_b128 v[116:119], v14 offset:8192
    ds_read_b128 v[120:123], v15 offset:8192
    ds_read_b128 v[124:127], v16 offset:8192
    s_waitcnt lgkmcnt(3)
    v_mfma_f32_16x16x32_bf16 v[136:139], v[112:115], v[80:83], v[136:139]
    s_waitcnt lgkmcnt(2)
    v_mfma_f32_16x16x32_bf16 v[136:139], v[116:119], v[84:87], v[136:139]
    s_waitcnt lgkmcnt(1)
    v_mfma_f32_16x16x32_bf16 v[136:139], v[120:123], v[88:91], v[136:139]
    s_waitcnt lgkmcnt(0)
    v_mfma_f32_16x16x32_bf16 v[136:139], v[124:127], v[92:95], v[136:139]
    s_nop 7
    v_cvt_pk_bf16_f32 v3, v136, v137
    v_cvt_pk_bf16_f32 v4, v138, v139
    v_lshlrev_b32 v136, 16, v3
    v_and_b32 v137, 0xffff0000, v3
    v_lshlrev_b32 v138, 16, v4
    v_and_b32 v139, 0xffff0000, v4
    v_mul_f32 v136, 0x3db504f3, v136
    v_mul_f32 v137, 0x3db504f3, v137
    v_mul_f32 v138, 0x3db504f3, v138
    v_mul_f32 v139, 0x3db504f3, v139
    v_cvt_pk_bf16_f32 v3, v136, v137
    v_cvt_pk_bf16_f32 v4, v138, v139
    v_lshlrev_b32 v136, 16, v3
    v_and_b32 v137, 0xffff0000, v3
    v_lshlrev_b32 v138, 16, v4
    v_and_b32 v139, 0xffff0000, v4
    s_add_u32 m0, s61, 20480
    s_xor_b32 s66, s60, 425984
    s_waitcnt vmcnt(7)
    buffer_load_dwordx4 v8, s[32:35], s66 offen offset:0 nt lds
    s_waitcnt vmcnt(7)
    buffer_load_dwordx4 v9, s[32:35], s66 offen offset:1024 nt lds
    s_waitcnt vmcnt(7)
    buffer_load_dwordx4 v10, s[32:35], s66 offen offset:2048 nt lds
    s_waitcnt vmcnt(7)
    buffer_load_dwordx4 v11, s[32:35], s66 offen offset:3072 nt lds
    ds_read_b128 v[96:99], v13 offset:12288
    ds_read_b128 v[100:103], v14 offset:12288
    ds_read_b128 v[104:107], v15 offset:12288
    ds_read_b128 v[108:111], v16 offset:12288
    s_waitcnt lgkmcnt(3)
    v_mfma_f32_16x16x32_bf16 v[140:143], v[96:99], v[32:35], 0
    s_waitcnt lgkmcnt(2)
    v_mfma_f32_16x16x32_bf16 v[140:143], v[100:103], v[36:39], v[140:143]
    s_waitcnt lgkmcnt(1)
    v_mfma_f32_16x16x32_bf16 v[140:143], v[104:107], v[40:43], v[140:143]
    s_waitcnt lgkmcnt(0)
    v_mfma_f32_16x16x32_bf16 v[140:143], v[108:111], v[44:47], v[140:143]
    s_add_u32 m0, s61, 24576
    s_xor_b32 s66, s60, 450560
    s_waitcnt vmcnt(7)
    buffer_load_dwordx4 v8, s[32:35], s66 offen offset:0 nt lds
    s_waitcnt vmcnt(7)
    buffer_load_dwordx4 v9, s[32:35], s66 offen offset:1024 nt lds
    s_waitcnt vmcnt(7)
    buffer_load_dwordx4 v10, s[32:35], s66 offen offset:2048 nt lds
    s_waitcnt vmcnt(7)
    buffer_load_dwordx4 v11, s[32:35], s66 offen offset:3072 nt lds
    ds_read_b128 v[112:115], v13 offset:16384
    ds_read_b128 v[116:119], v14 offset:16384
    ds_read_b128 v[120:123], v15 offset:16384
    ds_read_b128 v[124:127], v16 offset:16384
    s_waitcnt lgkmcnt(3)
    v_mfma_f32_16x16x32_bf16 v[140:143], v[112:115], v[48:51], v[140:143]
    s_waitcnt lgkmcnt(2)
    v_mfma_f32_16x16x32_bf16 v[140:143], v[116:119], v[52:55], v[140:143]
    s_waitcnt lgkmcnt(1)
    v_mfma_f32_16x16x32_bf16 v[140:143], v[120:123], v[56:59], v[140:143]
    s_waitcnt lgkmcnt(0)
    v_mfma_f32_16x16x32_bf16 v[140:143], v[124:127], v[60:63], v[140:143]
    s_xor_b32 s66, s60, 262144
    s_waitcnt vmcnt(7)
    buffer_load_dwordx4 a[128:131], v12, s[36:39], s66 offen offset:0 nt
    s_waitcnt vmcnt(7)
    buffer_load_dwordx4 a[132:135], v12, s[36:39], s66 offen offset:256 nt
    s_waitcnt vmcnt(7)
    buffer_load_dwordx4 a[136:139], v12, s[36:39], s66 offen offset:512 nt
    s_waitcnt vmcnt(7)
    buffer_load_dwordx4 a[140:143], v12, s[36:39], s66 offen offset:768 nt
    ds_read_b128 v[96:99], v13 offset:20480
    ds_read_b128 v[100:103], v14 offset:20480
    ds_read_b128 v[104:107], v15 offset:20480
    ds_read_b128 v[108:111], v16 offset:20480
    s_waitcnt lgkmcnt(3)
    v_mfma_f32_16x16x32_bf16 v[140:143], v[96:99], v[64:67], v[140:143]
    s_waitcnt lgkmcnt(2)
    v_mfma_f32_16x16x32_bf16 v[140:143], v[100:103], v[68:71], v[140:143]
    s_waitcnt lgkmcnt(1)
    v_mfma_f32_16x16x32_bf16 v[140:143], v[104:107], v[72:75], v[140:143]
    s_waitcnt lgkmcnt(0)
    v_mfma_f32_16x16x32_bf16 v[140:143], v[108:111], v[76:79], v[140:143]
    s_xor_b32 s66, s60, 286720
    s_waitcnt vmcnt(7)
    buffer_load_dwordx4 a[144:147], v12, s[36:39], s66 offen offset:0 nt
    s_waitcnt vmcnt(7)
    buffer_load_dwordx4 a[148:151], v12, s[36:39], s66 offen offset:256 nt
    s_waitcnt vmcnt(7)
    buffer_load_dwordx4 a[152:155], v12, s[36:39], s66 offen offset:512 nt
    s_waitcnt vmcnt(7)
    buffer_load_dwordx4 a[156:159], v12, s[36:39], s66 offen offset:768 nt
    ds_read_b128 v[112:115], v13 offset:24576
    ds_read_b128 v[116:119], v14 offset:24576
    ds_read_b128 v[120:123], v15 offset:24576
    ds_read_b128 v[124:127], v16 offset:24576
    s_waitcnt lgkmcnt(3)
    v_mfma_f32_16x16x32_bf16 v[140:143], v[112:115], v[80:83], v[140:143]
    s_waitcnt lgkmcnt(2)
    v_mfma_f32_16x16x32_bf16 v[140:143], v[116:119], v[84:87], v[140:143]
    s_waitcnt lgkmcnt(1)
    v_mfma_f32_16x16x32_bf16 v[140:143], v[120:123], v[88:91], v[140:143]
    s_waitcnt lgkmcnt(0)
    v_mfma_f32_16x16x32_bf16 v[140:143], v[124:127], v[92:95], v[140:143]
    s_nop 7
    v_cvt_pk_bf16_f32 v3, v140, v141
    v_cvt_pk_bf16_f32 v4, v142, v143
    v_lshlrev_b32 v140, 16, v3
    v_and_b32 v141, 0xffff0000, v3
    v_lshlrev_b32 v142, 16, v4
    v_and_b32 v143, 0xffff0000, v4
    v_mul_f32 v140, 0x3db504f3, v140
    v_mul_f32 v141, 0x3db504f3, v141
    v_mul_f32 v142, 0x3db504f3, v142
    v_mul_f32 v143, 0x3db504f3, v143
    v_cvt_pk_bf16_f32 v3, v140, v141
    v_cvt_pk_bf16_f32 v4, v142, v143
    v_lshlrev_b32 v140, 16, v3
    v_and_b32 v141, 0xffff0000, v3
    v_lshlrev_b32 v142, 16, v4
    v_and_b32 v143, 0xffff0000, v4
    v_max3_f32 v192, v128, v129, v130
    v_max3_f32 v192, v192, v131, v132
    v_max3_f32 v192, v192, v133, v134
    v_max3_f32 v192, v192, v135, v136
    v_max3_f32 v192, v192, v137, v138
    v_max3_f32 v192, v192, v139, v140
    v_max3_f32 v192, v192, v141, v142
    v_max_f32 v192, v192, v143
    s_lshl_b32 s67, s3, 8
    s_add_u32 s67, s67, 160256
    v_lshl_add_u32 v3, v1, 2, s67
    v_lshlrev_b32 v4, 2, v1
    v_add_u32 v4, 160256, v4
    v_max_f32_dpp v192, v192, v192 quad_perm:[1,0,3,2] row_mask:0xf bank_mask:0xf
    s_nop 1
    v_max_f32_dpp v192, v192, v192 quad_perm:[2,3,0,1] row_mask:0xf bank_mask:0xf
    v_mov_b32 v196, v192
    s_nop 1
    v_permlane16_swap_b32 v192, v196
    v_max_f32 v192, v192, v196
    v_mov_b32 v196, v192
    s_nop 1
    v_permlane32_swap_b32 v192, v196
    v_max_f32 v192, v192, v196
    ds_write_b32 v3, v192
    s_xor_b32 s66, s60, 294912
    s_waitcnt vmcnt(7)
    buffer_load_dwordx4 a[160:163], v12, s[36:39], s66 offen offset:0 nt
    s_waitcnt lgkmcnt(0)
    s_barrier
    ds_read_b32 v196, v4 offset:0
    ds_read_b32 v197, v4 offset:256
    ds_read_b32 v198, v4 offset:512
    ds_read_b32 v199, v4 offset:768
    s_lshr_b32 s68, s65, 2
    s_and_b32 s69, s65, 3
    s_lshl_b32 s67, s62, 13
    s_lshl_b32 s82, s68, 10
    s_add_u32 s67, s67, s82
    s_lshl_b32 s82, s3, 8
    s_add_u32 s67, s67, s82
    s_lshl_b32 s82, s69, 6
    s_add_u32 s67, s67, s82
    s_lshl_b32 s82, s64, 4
    s_add_u32 s67, s67, s82
    s_add_u32 s67, s67, 131072
    v_lshlrev_b32 v3, 11, v22
    s_waitcnt lgkmcnt(0)
    v_max3_f32 v192, v196, v197, v198
    v_max_f32 v192, v192, v199
    s_waitcnt vmcnt(7)
    buffer_load_dwordx4 a[164:167], v12, s[36:39], s66 offen offset:256 nt
    v_sub_f32 v128, v128, v192
    v_sub_f32 v129, v129, v192
    v_sub_f32 v130, v130, v192
    v_sub_f32 v131, v131, v192
    v_sub_f32 v132, v132, v192
    v_sub_f32 v133, v133, v192
    v_sub_f32 v134, v134, v192
    v_sub_f32 v135, v135, v192
    v_sub_f32 v136, v136, v192
    v_sub_f32 v137, v137, v192
    v_sub_f32 v138, v138, v192
    v_sub_f32 v139, v139, v192
    v_sub_f32 v140, v140, v192
    v_sub_f32 v141, v141, v192
    v_sub_f32 v142, v142, v192
    v_sub_f32 v143, v143, v192
    v_mul_f32 v128, 0x3fb8aa3b, v128
    v_mul_f32 v129, 0x3fb8aa3b, v129
    v_mul_f32 v130, 0x3fb8aa3b, v130
    v_mul_f32 v131, 0x3fb8aa3b, v131
    v_mul_f32 v132, 0x3fb8aa3b, v132
    v_mul_f32 v133, 0x3fb8aa3b, v133
    v_mul_f32 v134, 0x3fb8aa3b, v134
    v_mul_f32 v135, 0x3fb8aa3b, v135
    v_mul_f32 v136, 0x3fb8aa3b, v136
    v_mul_f32 v137, 0x3fb8aa3b, v137
    v_mul_f32 v138, 0x3fb8aa3b, v138
    v_mul_f32 v139, 0x3fb8aa3b, v139
    v_mul_f32 v140, 0x3fb8aa3b, v140
    v_mul_f32 v141, 0x3fb8aa3b, v141
    v_mul_f32 v142, 0x3fb8aa3b, v142
    v_mul_f32 v143, 0x3fb8aa3b, v143
    s_waitcnt vmcnt(7)
    buffer_load_dwordx4 a[168:171], v12, s[36:39], s66 offen offset:512 nt
    v_exp_f32 v128, v128
    v_exp_f32 v129, v129
    v_exp_f32 v130, v130
    v_exp_f32 v131, v131
    v_exp_f32 v132, v132
    v_exp_f32 v133, v133
    v_exp_f32 v134, v134
    v_exp_f32 v135, v135
    v_exp_f32 v136, v136
    v_exp_f32 v137, v137
    v_exp_f32 v138, v138
    v_exp_f32 v139, v139
    v_exp_f32 v140, v140
    v_exp_f32 v141, v141
    v_exp_f32 v142, v142
    v_exp_f32 v143, v143
    s_waitcnt vmcnt(7)
    buffer_load_dwordx4 a[172:175], v12, s[36:39], s66 offen offset:768 nt
    v_cvt_pk_bf16_f32 v144, v128, v128
    v_cvt_pk_bf16_f32 v145, v129, v129
    v_cvt_pk_bf16_f32 v146, v130, v130
    v_cvt_pk_bf16_f32 v147, v131, v131
    v_cvt_pk_bf16_f32 v148, v132, v132
    v_cvt_pk_bf16_f32 v149, v133, v133
    v_cvt_pk_bf16_f32 v150, v134, v134
    v_cvt_pk_bf16_f32 v151, v135, v135
    v_cvt_pk_bf16_f32 v152, v136, v136
    v_cvt_pk_bf16_f32 v153, v137, v137
    v_cvt_pk_bf16_f32 v154, v138, v138
    v_cvt_pk_bf16_f32 v155, v139, v139
    v_cvt_pk_bf16_f32 v156, v140, v140
    v_cvt_pk_bf16_f32 v157, v141, v141
    v_cvt_pk_bf16_f32 v158, v142, v142
    v_cvt_pk_bf16_f32 v159, v143, v143
    v_pk_add_f32 v[128:129], v[128:129], v[136:137]
    v_pk_add_f32 v[130:131], v[130:131], v[138:139]
    v_pk_add_f32 v[132:133], v[132:133], v[140:141]
    v_pk_add_f32 v[134:135], v[134:135], v[142:143]
    v_pk_add_f32 v[128:129], v[128:129], v[132:133]
    v_pk_add_f32 v[130:131], v[130:131], v[134:135]
    v_pk_add_f32 v[128:129], v[128:129], v[130:131]
    v_add_f32 v193, v128, v129
    v_mov_b32 v194, s80
    v_mov_b32 v195, s81
    v_add_f32_dpp v193, v193, v193 quad_perm:[1,0,3,2] row_mask:0xf bank_mask:0xf
    s_nop 1
    v_add_f32_dpp v193, v193, v193 quad_perm:[2,3,0,1] row_mask:0xf bank_mask:0xf
    v_mov_b32 v196, v193
    s_nop 1
    v_permlane16_swap_b32 v193, v196
    v_add_f32 v193, v193, v196
    v_mov_b32 v196, v193
    s_nop 1
    v_permlane32_swap_b32 v193, v196
    v_add_f32 v193, v193, v196
    s_mov_b64 exec, 0x1111
    s_cmp_eq_u32 s83, 0
    s_cbranch_scc1 SLOW_3
    buffer_store_dwordx4 v[192:195], v3, s[40:43], s67 offen
BACK_4:
    s_mov_b64 exec, -1
    s_xor_b32 s66, s60, 319488
    s_waitcnt vmcnt(8)
    buffer_load_dwordx4 a[176:179], v12, s[36:39], s66 offen offset:0 nt
    s_getpc_b64 s[4:5]
PC_5:
    s_add_u32 s4, s4, L_TAIL-PC_5
    s_addc_u32 s5, s5, 0
    s_lshl_b32 s6, s63, 9
    s_lshl_b32 s82, s3, 7
    s_add_u32 s6, s6, s82
    s_min_u32 s6, s6, L_END-L_TAIL-64
    s_load_dword s9, s[4:5], s6
    s_add_u32 s6, s6, 64
    s_load_dword s10, s[4:5], s6
    v_and_b32_dpp v160, v144, v17 quad_perm:[0,0,0,0] row_mask:0xf bank_mask:0xf
    v_and_b32_dpp v161, v144, v18 quad_perm:[0,0,0,0] row_mask:0xf bank_mask:0xf
    v_and_b32_dpp v162, v145, v17 quad_perm:[0,0,0,0] row_mask:0xf bank_mask:0xf
    v_and_b32_dpp v163, v145, v18 quad_perm:[0,0,0,0] row_mask:0xf bank_mask:0xf
    v_and_b32_dpp v164, v146, v17 quad_perm:[0,0,0,0] row_mask:0xf bank_mask:0xf
    v_and_b32_dpp v165, v146, v18 quad_perm:[0,0,0,0] row_mask:0xf bank_mask:0xf
    v_and_b32_dpp v166, v147, v17 quad_perm:[0,0,0,0] row_mask:0xf bank_mask:0xf
    v_and_b32_dpp v167, v147, v18 quad_perm:[0,0,0,0] row_mask:0xf bank_mask:0xf
    v_mfma_f32_16x16x16_bf16 v[24:27], v[160:161], a[0:1], 0
    v_mfma_f32_16x16x16_bf16 v[28:31], v[160:161], a[2:3], 0
    v_mfma_f32_16x16x16_bf16 v[24:27], v[162:163], a[4:5], v[24:27]
    v_mfma_f32_16x16x16_bf16 v[28:31], v[162:163], a[6:7], v[28:31]
    v_mfma_f32_16x16x16_bf16 v[24:27], v[164:165], a[8:9], v[24:27]
    v_mfma_f32_16x16x16_bf16 v[28:31], v[164:165], a[10:11], v[28:31]
    v_mfma_f32_16x16x16_bf16 v[24:27], v[166:167], a[12:13], v[24:27]
    v_mfma_f32_16x16x16_bf16 v[28:31], v[166:167], a[14:15], v[28:31]
    s_waitcnt vmcnt(8)
    buffer_load_dwordx4 a[180:183], v12, s[36:39], s66 offen offset:256 nt
    s_cmp_lg_u32 s3, 0
    s_cbranch_scc1 AT_6
    s_mov_b64 exec, 1
    s_lshl_b32 s67, s62, 5
    v_mov_b32 v3, s67
    v_mov_b32 v4, 1
    global_atomic_add v223, v3, v4, s[26:27] sc0 sc1
    s_mov_b64 exec, -1
AT_6:
    v_and_b32_dpp v160, v144, v17 quad_perm:[1,1,1,1] row_mask:0xf bank_mask:0xf
    v_and_b32_dpp v161, v144, v18 quad_perm:[1,1,1,1] row_mask:0xf bank_mask:0xf
    v_and_b32_dpp v162, v145, v17 quad_perm:[1,1,1,1] row_mask:0xf bank_mask:0xf
    v_and_b32_dpp v163, v145, v18 quad_perm:[1,1,1,1] row_mask:0xf bank_mask:0xf
    v_and_b32_dpp v164, v146, v17 quad_perm:[1,1,1,1] row_mask:0xf bank_mask:0xf
    v_and_b32_dpp v165, v146, v18 quad_perm:[1,1,1,1] row_mask:0xf bank_mask:0xf
    v_and_b32_dpp v166, v147, v17 quad_perm:[1,1,1,1] row_mask:0xf bank_mask:0xf
    v_and_b32_dpp v167, v147, v18 quad_perm:[1,1,1,1] row_mask:0xf bank_mask:0xf
    v_mfma_f32_16x16x16_bf16 v[24:27], v[160:161], a[16:17], v[24:27]
    v_mfma_f32_16x16x16_bf16 v[28:31], v[160:161], a[18:19], v[28:31]
    v_mfma_f32_16x16x16_bf16 v[24:27], v[162:163], a[20:21], v[24:27]
    v_mfma_f32_16x16x16_bf16 v[28:31], v[162:163], a[22:23], v[28:31]
    v_mfma_f32_16x16x16_bf16 v[24:27], v[164:165], a[24:25], v[24:27]
    v_mfma_f32_16x16x16_bf16 v[28:31], v[164:165], a[26:27], v[28:31]
    v_mfma_f32_16x16x16_bf16 v[24:27], v[166:167], a[28:29], v[24:27]
    v_mfma_f32_16x16x16_bf16 v[28:31], v[166:167], a[30:31], v[28:31]
    s_waitcnt vmcnt(8)
    buffer_load_dwordx4 a[184:187], v12, s[36:39], s66 offen offset:512 nt
    v_and_b32_dpp v160, v144, v17 quad_perm:[2,2,2,2] row_mask:0xf bank_mask:0xf
    v_and_b32_dpp v161, v144, v18 quad_perm:[2,2,2,2] row_mask:0xf bank_mask:0xf
    v_and_b32_dpp v162, v145, v17 quad_perm:[2,2,2,2] row_mask:0xf bank_mask:0xf
    v_and_b32_dpp v163, v145, v18 quad_perm:[2,2,2,2] row_mask:0xf bank_mask:0xf
    v_and_b32_dpp v164, v146, v17 quad_perm:[2,2,2,2] row_mask:0xf bank_mask:0xf
    v_and_b32_dpp v165, v146, v18 quad_perm:[2,2,2,2] row_mask:0xf bank_mask:0xf
    v_and_b32_dpp v166, v147, v17 quad_perm:[2,2,2,2] row_mask:0xf bank_mask:0xf
    v_and_b32_dpp v167, v147, v18 quad_perm:[2,2,2,2] row_mask:0xf bank_mask:0xf
    v_mfma_f32_16x16x16_bf16 v[24:27], v[160:161], a[32:33], v[24:27]
    v_mfma_f32_16x16x16_bf16 v[28:31], v[160:161], a[34:35], v[28:31]
    v_mfma_f32_16x16x16_bf16 v[24:27], v[162:163], a[36:37], v[24:27]
    v_mfma_f32_16x16x16_bf16 v[28:31], v[162:163], a[38:39], v[28:31]
    v_mfma_f32_16x16x16_bf16 v[24:27], v[164:165], a[40:41], v[24:27]
    v_mfma_f32_16x16x16_bf16 v[28:31], v[164:165], a[42:43], v[28:31]
    v_mfma_f32_16x16x16_bf16 v[24:27], v[166:167], a[44:45], v[24:27]
    v_mfma_f32_16x16x16_bf16 v[28:31], v[166:167], a[46:47], v[28:31]
    s_waitcnt vmcnt(8)
    buffer_load_dwordx4 a[188:191], v12, s[36:39], s66 offen offset:768 nt
    v_and_b32_dpp v160, v144, v17 quad_perm:[3,3,3,3] row_mask:0xf bank_mask:0xf
    v_and_b32_dpp v161, v144, v18 quad_perm:[3,3,3,3] row_mask:0xf bank_mask:0xf
    v_and_b32_dpp v162, v145, v17 quad_perm:[3,3,3,3] row_mask:0xf bank_mask:0xf
    v_and_b32_dpp v163, v145, v18 quad_perm:[3,3,3,3] row_mask:0xf bank_mask:0xf
    v_and_b32_dpp v164, v146, v17 quad_perm:[3,3,3,3] row_mask:0xf bank_mask:0xf
    v_and_b32_dpp v165, v146, v18 quad_perm:[3,3,3,3] row_mask:0xf bank_mask:0xf
    v_and_b32_dpp v166, v147, v17 quad_perm:[3,3,3,3] row_mask:0xf bank_mask:0xf
    v_and_b32_dpp v167, v147, v18 quad_perm:[3,3,3,3] row_mask:0xf bank_mask:0xf
    v_mfma_f32_16x16x16_bf16 v[24:27], v[160:161], a[48:49], v[24:27]
    v_mfma_f32_16x16x16_bf16 v[28:31], v[160:161], a[50:51], v[28:31]
    v_mfma_f32_16x16x16_bf16 v[24:27], v[162:163], a[52:53], v[24:27]
    v_mfma_f32_16x16x16_bf16 v[28:31], v[162:163], a[54:55], v[28:31]
    v_mfma_f32_16x16x16_bf16 v[24:27], v[164:165], a[56:57], v[24:27]
    v_mfma_f32_16x16x16_bf16 v[28:31], v[164:165], a[58:59], v[28:31]
    v_mfma_f32_16x16x16_bf16 v[24:27], v[166:167], a[60:61], v[24:27]
    v_mfma_f32_16x16x16_bf16 v[28:31], v[166:167], a[62:63], v[28:31]
    s_xor_b32 s66, s60, 393216
    s_waitcnt vmcnt(8)
    buffer_load_dwordx4 a[192:195], v12, s[36:39], s66 offen offset:0 nt
    v_and_b32_dpp v160, v148, v17 quad_perm:[0,0,0,0] row_mask:0xf bank_mask:0xf
    v_and_b32_dpp v161, v148, v18 quad_perm:[0,0,0,0] row_mask:0xf bank_mask:0xf
    v_and_b32_dpp v162, v149, v17 quad_perm:[0,0,0,0] row_mask:0xf bank_mask:0xf
    v_and_b32_dpp v163, v149, v18 quad_perm:[0,0,0,0] row_mask:0xf bank_mask:0xf
    v_and_b32_dpp v164, v150, v17 quad_perm:[0,0,0,0] row_mask:0xf bank_mask:0xf
    v_and_b32_dpp v165, v150, v18 quad_perm:[0,0,0,0] row_mask:0xf bank_mask:0xf
    v_and_b32_dpp v166, v151, v17 quad_perm:[0,0,0,0] row_mask:0xf bank_mask:0xf
    v_and_b32_dpp v167, v151, v18 quad_perm:[0,0,0,0] row_mask:0xf bank_mask:0xf
    v_mfma_f32_16x16x16_bf16 v[24:27], v[160:161], a[64:65], v[24:27]
    v_mfma_f32_16x16x16_bf16 v[28:31], v[160:161], a[66:67], v[28:31]
    v_mfma_f32_16x16x16_bf16 v[24:27], v[162:163], a[68:69], v[24:27]
    v_mfma_f32_16x16x16_bf16 v[28:31], v[162:163], a[70:71], v[28:31]
    v_mfma_f32_16x16x16_bf16 v[24:27], v[164:165], a[72:73], v[24:27]
    v_mfma_f32_16x16x16_bf16 v[28:31], v[164:165], a[74:75], v[28:31]
    v_mfma_f32_16x16x16_bf16 v[24:27], v[166:167], a[76:77], v[24:27]
    v_mfma_f32_16x16x16_bf16 v[28:31], v[166:167], a[78:79], v[28:31]
    s_waitcnt vmcnt(8)
    buffer_load_dwordx4 a[196:199], v12, s[36:39], s66 offen offset:256 nt
    v_and_b32_dpp v160, v148, v17 quad_perm:[1,1,1,1] row_mask:0xf bank_mask:0xf
    v_and_b32_dpp v161, v148, v18 quad_perm:[1,1,1,1] row_mask:0xf bank_mask:0xf
    v_and_b32_dpp v162, v149, v17 quad_perm:[1,1,1,1] row_mask:0xf bank_mask:0xf
    v_and_b32_dpp v163, v149, v18 quad_perm:[1,1,1,1] row_mask:0xf bank_mask:0xf
    v_and_b32_dpp v164, v150, v17 quad_perm:[1,1,1,1] row_mask:0xf bank_mask:0xf
    v_and_b32_dpp v165, v150, v18 quad_perm:[1,1,1,1] row_mask:0xf bank_mask:0xf
    v_and_b32_dpp v166, v151, v17 quad_perm:[1,1,1,1] row_mask:0xf bank_mask:0xf
    v_and_b32_dpp v167, v151, v18 quad_perm:[1,1,1,1] row_mask:0xf bank_mask:0xf
    v_mfma_f32_16x16x16_bf16 v[24:27], v[160:161], a[80:81], v[24:27]
    v_mfma_f32_16x16x16_bf16 v[28:31], v[160:161], a[82:83], v[28:31]
    v_mfma_f32_16x16x16_bf16 v[24:27], v[162:163], a[84:85], v[24:27]
    v_mfma_f32_16x16x16_bf16 v[28:31], v[162:163], a[86:87], v[28:31]
    v_mfma_f32_16x16x16_bf16 v[24:27], v[164:165], a[88:89], v[24:27]
    v_mfma_f32_16x16x16_bf16 v[28:31], v[164:165], a[90:91], v[28:31]
    v_mfma_f32_16x16x16_bf16 v[24:27], v[166:167], a[92:93], v[24:27]
    v_mfma_f32_16x16x16_bf16 v[28:31], v[166:167], a[94:95], v[28:31]
    s_waitcnt vmcnt(8)
    buffer_load_dwordx4 a[200:203], v12, s[36:39], s66 offen offset:512 nt
    v_and_b32_dpp v160, v148, v17 quad_perm:[2,2,2,2] row_mask:0xf bank_mask:0xf
    v_and_b32_dpp v161, v148, v18 quad_perm:[2,2,2,2] row_mask:0xf bank_mask:0xf
    v_and_b32_dpp v162, v149, v17 quad_perm:[2,2,2,2] row_mask:0xf bank_mask:0xf
    v_and_b32_dpp v163, v149, v18 quad_perm:[2,2,2,2] row_mask:0xf bank_mask:0xf
    v_and_b32_dpp v164, v150, v17 quad_perm:[2,2,2,2] row_mask:0xf bank_mask:0xf
    v_and_b32_dpp v165, v150, v18 quad_perm:[2,2,2,2] row_mask:0xf bank_mask:0xf
    v_and_b32_dpp v166, v151, v17 quad_perm:[2,2,2,2] row_mask:0xf bank_mask:0xf
    v_and_b32_dpp v167, v151, v18 quad_perm:[2,2,2,2] row_mask:0xf bank_mask:0xf
    v_mfma_f32_16x16x16_bf16 v[24:27], v[160:161], a[96:97], v[24:27]
    v_mfma_f32_16x16x16_bf16 v[28:31], v[160:161], a[98:99], v[28:31]
    v_mfma_f32_16x16x16_bf16 v[24:27], v[162:163], a[100:101], v[24:27]
    v_mfma_f32_16x16x16_bf16 v[28:31], v[162:163], a[102:103], v[28:31]
    v_mfma_f32_16x16x16_bf16 v[24:27], v[164:165], a[104:105], v[24:27]
    v_mfma_f32_16x16x16_bf16 v[28:31], v[164:165], a[106:107], v[28:31]
    v_mfma_f32_16x16x16_bf16 v[24:27], v[166:167], a[108:109], v[24:27]
    v_mfma_f32_16x16x16_bf16 v[28:31], v[166:167], a[110:111], v[28:31]
    s_waitcnt vmcnt(8)
    buffer_load_dwordx4 a[204:207], v12, s[36:39], s66 offen offset:768 nt
    v_and_b32_dpp v160, v148, v17 quad_perm:[3,3,3,3] row_mask:0xf bank_mask:0xf
    v_and_b32_dpp v161, v148, v18 quad_perm:[3,3,3,3] row_mask:0xf bank_mask:0xf
    v_and_b32_dpp v162, v149, v17 quad_perm:[3,3,3,3] row_mask:0xf bank_mask:0xf
    v_and_b32_dpp v163, v149, v18 quad_perm:[3,3,3,3] row_mask:0xf bank_mask:0xf
    v_and_b32_dpp v164, v150, v17 quad_perm:[3,3,3,3] row_mask:0xf bank_mask:0xf
    v_and_b32_dpp v165, v150, v18 quad_perm:[3,3,3,3] row_mask:0xf bank_mask:0xf
    v_and_b32_dpp v166, v151, v17 quad_perm:[3,3,3,3] row_mask:0xf bank_mask:0xf
    v_and_b32_dpp v167, v151, v18 quad_perm:[3,3,3,3] row_mask:0xf bank_mask:0xf
    v_mfma_f32_16x16x16_bf16 v[24:27], v[160:161], a[112:113], v[24:27]
    v_mfma_f32_16x16x16_bf16 v[28:31], v[160:161], a[114:115], v[28:31]
    v_mfma_f32_16x16x16_bf16 v[24:27], v[162:163], a[116:117], v[24:27]
    v_mfma_f32_16x16x16_bf16 v[28:31], v[162:163], a[118:119], v[28:31]
    v_mfma_f32_16x16x16_bf16 v[24:27], v[164:165], a[120:121], v[24:27]
    v_mfma_f32_16x16x16_bf16 v[28:31], v[164:165], a[122:123], v[28:31]
    v_mfma_f32_16x16x16_bf16 v[24:27], v[166:167], a[124:125], v[24:27]
    v_mfma_f32_16x16x16_bf16 v[28:31], v[166:167], a[126:127], v[28:31]
    s_xor_b32 s66, s60, 417792
    s_waitcnt vmcnt(7)
    buffer_load_dwordx4 a[208:211], v12, s[36:39], s66 offen offset:0 nt
    v_and_b32_dpp v160, v152, v17 quad_perm:[0,0,0,0] row_mask:0xf bank_mask:0xf
    v_and_b32_dpp v161, v152, v18 quad_perm:[0,0,0,0] row_mask:0xf bank_mask:0xf
    v_and_b32_dpp v162, v153, v17 quad_perm:[0,0,0,0] row_mask:0xf bank_mask:0xf
    v_and_b32_dpp v163, v153, v18 quad_perm:[0,0,0,0] row_mask:0xf bank_mask:0xf
    v_and_b32_dpp v164, v154, v17 quad_perm:[0,0,0,0] row_mask:0xf bank_mask:0xf
    v_and_b32_dpp v165, v154, v18 quad_perm:[0,0,0,0] row_mask:0xf bank_mask:0xf
    v_and_b32_dpp v166, v155, v17 quad_perm:[0,0,0,0] row_mask:0xf bank_mask:0xf
    v_and_b32_dpp v167, v155, v18 quad_perm:[0,0,0,0] row_mask:0xf bank_mask:0xf
    v_mfma_f32_16x16x16_bf16 v[24:27], v[160:161], a[128:129], v[24:27]
    v_mfma_f32_16x16x16_bf16 v[28:31], v[160:161], a[130:131], v[28:31]
    v_mfma_f32_16x16x16_bf16 v[24:27], v[162:163], a[132:133], v[24:27]
    v_mfma_f32_16x16x16_bf16 v[28:31], v[162:163], a[134:135], v[28:31]
    v_mfma_f32_16x16x16_bf16 v[24:27], v[164:165], a[136:137], v[24:27]
    v_mfma_f32_16x16x16_bf16 v[28:31], v[164:165], a[138:139], v[28:31]
    v_mfma_f32_16x16x16_bf16 v[24:27], v[166:167], a[140:141], v[24:27]
    v_mfma_f32_16x16x16_bf16 v[28:31], v[166:167], a[142:143], v[28:31]
    s_waitcnt vmcnt(7)
    buffer_load_dwordx4 a[212:215], v12, s[36:39], s66 offen offset:256 nt
    v_and_b32_dpp v160, v152, v17 quad_perm:[1,1,1,1] row_mask:0xf bank_mask:0xf
    v_and_b32_dpp v161, v152, v18 quad_perm:[1,1,1,1] row_mask:0xf bank_mask:0xf
    v_and_b32_dpp v162, v153, v17 quad_perm:[1,1,1,1] row_mask:0xf bank_mask:0xf
    v_and_b32_dpp v163, v153, v18 quad_perm:[1,1,1,1] row_mask:0xf bank_mask:0xf
    v_and_b32_dpp v164, v154, v17 quad_perm:[1,1,1,1] row_mask:0xf bank_mask:0xf
    v_and_b32_dpp v165, v154, v18 quad_perm:[1,1,1,1] row_mask:0xf bank_mask:0xf
    v_and_b32_dpp v166, v155, v17 quad_perm:[1,1,1,1] row_mask:0xf bank_mask:0xf
    v_and_b32_dpp v167, v155, v18 quad_perm:[1,1,1,1] row_mask:0xf bank_mask:0xf
    v_mfma_f32_16x16x16_bf16 v[24:27], v[160:161], a[144:145], v[24:27]
    v_mfma_f32_16x16x16_bf16 v[28:31], v[160:161], a[146:147], v[28:31]
    v_mfma_f32_16x16x16_bf16 v[24:27], v[162:163], a[148:149], v[24:27]
    v_mfma_f32_16x16x16_bf16 v[28:31], v[162:163], a[150:151], v[28:31]
    v_mfma_f32_16x16x16_bf16 v[24:27], v[164:165], a[152:153], v[24:27]
    v_mfma_f32_16x16x16_bf16 v[28:31], v[164:165], a[154:155], v[28:31]
    v_mfma_f32_16x16x16_bf16 v[24:27], v[166:167], a[156:157], v[24:27]
    v_mfma_f32_16x16x16_bf16 v[28:31], v[166:167], a[158:159], v[28:31]
    s_waitcnt vmcnt(7)
    buffer_load_dwordx4 a[216:219], v12, s[36:39], s66 offen offset:512 nt
    v_and_b32_dpp v160, v152, v17 quad_perm:[2,2,2,2] row_mask:0xf bank_mask:0xf
    v_and_b32_dpp v161, v152, v18 quad_perm:[2,2,2,2] row_mask:0xf bank_mask:0xf
    v_and_b32_dpp v162, v153, v17 quad_perm:[2,2,2,2] row_mask:0xf bank_mask:0xf
    v_and_b32_dpp v163, v153, v18 quad_perm:[2,2,2,2] row_mask:0xf bank_mask:0xf
    v_and_b32_dpp v164, v154, v17 quad_perm:[2,2,2,2] row_mask:0xf bank_mask:0xf
    v_and_b32_dpp v165, v154, v18 quad_perm:[2,2,2,2] row_mask:0xf bank_mask:0xf
    v_and_b32_dpp v166, v155, v17 quad_perm:[2,2,2,2] row_mask:0xf bank_mask:0xf
    v_and_b32_dpp v167, v155, v18 quad_perm:[2,2,2,2] row_mask:0xf bank_mask:0xf
    v_mfma_f32_16x16x16_bf16 v[24:27], v[160:161], a[160:161], v[24:27]
    v_mfma_f32_16x16x16_bf16 v[28:31], v[160:161], a[162:163], v[28:31]
    v_mfma_f32_16x16x16_bf16 v[24:27], v[162:163], a[164:165], v[24:27]
    v_mfma_f32_16x16x16_bf16 v[28:31], v[162:163], a[166:167], v[28:31]
    v_mfma_f32_16x16x16_bf16 v[24:27], v[164:165], a[168:169], v[24:27]
    v_mfma_f32_16x16x16_bf16 v[28:31], v[164:165], a[170:171], v[28:31]
    v_mfma_f32_16x16x16_bf16 v[24:27], v[166:167], a[172:173], v[24:27]
    v_mfma_f32_16x16x16_bf16 v[28:31], v[166:167], a[174:175], v[28:31]
    s_waitcnt vmcnt(7)
    buffer_load_dwordx4 a[220:223], v12, s[36:39], s66 offen offset:768 nt
    v_mov_b32 v3, 163328
    s_cmp_lg_u32 s3, 0
    s_cbranch_scc1 RK_7
    s_waitcnt vmcnt(10)
    s_mov_b64 exec, 1
    ds_write_b32 v3, v223
    s_mov_b64 exec, -1
    s_waitcnt lgkmcnt(0)
RK_7:
    s_barrier
    ds_read_b32 v223, v3
    v_and_b32_dpp v160, v152, v17 quad_perm:[3,3,3,3] row_mask:0xf bank_mask:0xf
    v_and_b32_dpp v161, v152, v18 quad_perm:[3,3,3,3] row_mask:0xf bank_mask:0xf
    v_and_b32_dpp v162, v153, v17 quad_perm:[3,3,3,3] row_mask:0xf bank_mask:0xf
    v_and_b32_dpp v163, v153, v18 quad_perm:[3,3,3,3] row_mask:0xf bank_mask:0xf
    v_and_b32_dpp v164, v154, v17 quad_perm:[3,3,3,3] row_mask:0xf bank_mask:0xf
    v_and_b32_dpp v165, v154, v18 quad_perm:[3,3,3,3] row_mask:0xf bank_mask:0xf
    v_and_b32_dpp v166, v155, v17 quad_perm:[3,3,3,3] row_mask:0xf bank_mask:0xf
    v_and_b32_dpp v167, v155, v18 quad_perm:[3,3,3,3] row_mask:0xf bank_mask:0xf
    v_mfma_f32_16x16x16_bf16 v[24:27], v[160:161], a[176:177], v[24:27]
    v_mfma_f32_16x16x16_bf16 v[28:31], v[160:161], a[178:179], v[28:31]
    v_mfma_f32_16x16x16_bf16 v[24:27], v[162:163], a[180:181], v[24:27]
    v_mfma_f32_16x16x16_bf16 v[28:31], v[162:163], a[182:183], v[28:31]
    v_mfma_f32_16x16x16_bf16 v[24:27], v[164:165], a[184:185], v[24:27]
    v_mfma_f32_16x16x16_bf16 v[28:31], v[164:165], a[186:187], v[28:31]
    v_mfma_f32_16x16x16_bf16 v[24:27], v[166:167], a[188:189], v[24:27]
    v_mfma_f32_16x16x16_bf16 v[28:31], v[166:167], a[190:191], v[28:31]
    s_xor_b32 s66, s60, 425984
    s_waitcnt vmcnt(7)
    buffer_load_dwordx4 a[224:227], v12, s[36:39], s66 offen offset:0 nt
    s_waitcnt lgkmcnt(0)
    v_readfirstlane_b32 s0, v223
    s_nop 0
    s_and_b32 s0, s0, 31
    s_lshr_b32 s67, s0, 4
    s_cmp_ge_u32 s3, s67
    s_cbranch_scc1 A2_8
    s_mov_b64 exec, 1
    v_mov_b32 v3, 16
    v_mov_b32 v4, 1
    global_atomic_add v223, v3, v4, s[26:27] sc0 sc1
    s_mov_b64 exec, -1
A2_8:
    s_waitcnt vmcnt(7)
    buffer_load_dwordx4 a[228:231], v12, s[36:39], s66 offen offset:256 nt
    s_waitcnt vmcnt(7)
    buffer_load_dwordx4 a[232:235], v12, s[36:39], s66 offen offset:512 nt
    s_waitcnt vmcnt(7)
    buffer_load_dwordx4 a[236:239], v12, s[36:39], s66 offen offset:768 nt
    v_and_b32_dpp v160, v156, v17 quad_perm:[0,0,0,0] row_mask:0xf bank_mask:0xf
    v_and_b32_dpp v161, v156, v18 quad_perm:[0,0,0,0] row_mask:0xf bank_mask:0xf
    v_and_b32_dpp v162, v157, v17 quad_perm:[0,0,0,0] row_mask:0xf bank_mask:0xf
    v_and_b32_dpp v163, v157, v18 quad_perm:[0,0,0,0] row_mask:0xf bank_mask:0xf
    v_and_b32_dpp v164, v158, v17 quad_perm:[0,0,0,0] row_mask:0xf bank_mask:0xf
    v_and_b32_dpp v165, v158, v18 quad_perm:[0,0,0,0] row_mask:0xf bank_mask:0xf
    v_and_b32_dpp v166, v159, v17 quad_perm:[0,0,0,0] row_mask:0xf bank_mask:0xf
    v_and_b32_dpp v167, v159, v18 quad_perm:[0,0,0,0] row_mask:0xf bank_mask:0xf
    v_mfma_f32_16x16x16_bf16 v[24:27], v[160:161], a[192:193], v[24:27]
    v_mfma_f32_16x16x16_bf16 v[28:31], v[160:161], a[194:195], v[28:31]
    v_mfma_f32_16x16x16_bf16 v[24:27], v[162:163], a[196:197], v[24:27]
    v_mfma_f32_16x16x16_bf16 v[28:31], v[162:163], a[198:199], v[28:31]
    v_mfma_f32_16x16x16_bf16 v[24:27], v[164:165], a[200:201], v[24:27]
    v_mfma_f32_16x16x16_bf16 v[28:31], v[164:165], a[202:203], v[28:31]
    v_mfma_f32_16x16x16_bf16 v[24:27], v[166:167], a[204:205], v[24:27]
    v_mfma_f32_16x16x16_bf16 v[28:31], v[166:167], a[206:207], v[28:31]
    s_xor_b32 s66, s60, 450560
    s_waitcnt vmcnt(7)
    buffer_load_dwordx4 a[240:243], v12, s[36:39], s66 offen offset:0 nt
    s_waitcnt vmcnt(7)
    buffer_load_dwordx4 a[244:247], v12, s[36:39], s66 offen offset:256 nt
    s_waitcnt vmcnt(7)
    buffer_load_dwordx4 a[248:251], v12, s[36:39], s66 offen offset:512 nt
    s_waitcnt vmcnt(7)
    buffer_load_dwordx4 a[252:255], v12, s[36:39], s66 offen offset:768 nt
    v_and_b32_dpp v160, v156, v17 quad_perm:[1,1,1,1] row_mask:0xf bank_mask:0xf
    v_and_b32_dpp v161, v156, v18 quad_perm:[1,1,1,1] row_mask:0xf bank_mask:0xf
    v_and_b32_dpp v162, v157, v17 quad_perm:[1,1,1,1] row_mask:0xf bank_mask:0xf
    v_and_b32_dpp v163, v157, v18 quad_perm:[1,1,1,1] row_mask:0xf bank_mask:0xf
    v_and_b32_dpp v164, v158, v17 quad_perm:[1,1,1,1] row_mask:0xf bank_mask:0xf
    v_and_b32_dpp v165, v158, v18 quad_perm:[1,1,1,1] row_mask:0xf bank_mask:0xf
    v_and_b32_dpp v166, v159, v17 quad_perm:[1,1,1,1] row_mask:0xf bank_mask:0xf
    v_and_b32_dpp v167, v159, v18 quad_perm:[1,1,1,1] row_mask:0xf bank_mask:0xf
    v_mfma_f32_16x16x16_bf16 v[24:27], v[160:161], a[208:209], v[24:27]
    v_mfma_f32_16x16x16_bf16 v[28:31], v[160:161], a[210:211], v[28:31]
    v_mfma_f32_16x16x16_bf16 v[24:27], v[162:163], a[212:213], v[24:27]
    v_mfma_f32_16x16x16_bf16 v[28:31], v[162:163], a[214:215], v[28:31]
    v_mfma_f32_16x16x16_bf16 v[24:27], v[164:165], a[216:217], v[24:27]
    v_mfma_f32_16x16x16_bf16 v[28:31], v[164:165], a[218:219], v[28:31]
    v_mfma_f32_16x16x16_bf16 v[24:27], v[166:167], a[220:221], v[24:27]
    v_mfma_f32_16x16x16_bf16 v[28:31], v[166:167], a[222:223], v[28:31]
L_TAIL:
    v_mov_b32 v0, 0
    s_cmp_lt_u32 s0, 16
    s_cbranch_scc1 L_B
    s_mov_b32 s32, s22
    s_mov_b32 s33, s23
    s_mov_b32 s34, 0x400
    s_mov_b32 s35, 0x20000
    s_lshl_b32 s67, s3, 10
    v_lshlrev_b32 v6, 3, v1
    buffer_load_dwordx2 v[240:241], v6, s[44:47], s67 offen offset:0
    buffer_load_dwordx2 v[242:243], v6, s[44:47], s67 offen offset:512
    buffer_load_dwordx2 v[244:245], v6, s[32:35], 0 offen offset:0
    buffer_load_dwordx2 v[246:247], v6, s[32:35], 0 offen offset:512
    s_lshl_b32 s67, s3, 11
    s_add_u32 s67, s67, 152064
    v_add_u32 v3, s67, v2
    v_lshrrev_b32 v6, 2, v1
    v_bfe_u32 v5, v1, 1, 1
    v_and_b32 v7, 1, v1
    s_lshl_b32 s67, s3, 8
    s_add_u32 s67, s67, 152064
    v_lshl_add_u32 v4, v6, 4, s67
    v_lshl_add_u32 v4, v5, 10, v4
    v_lshl_add_u32 v4, v7, 3, v4
    s_lshl_b32 s67, s62, 15
    s_lshl_b32 s82, s65, 12
    s_add_u32 s67, s67, s82
    s_lshl_b32 s82, s3, 10
    s_add_u32 s67, s67, s82
    s_lshl_b32 s82, s64, 4
    s_add_u32 s67, s67, s82
    s_add_u32 s67, s67, 262144
    v_lshlrev_b32 v5, 6, v6
    v_lshl_add_u32 v5, v21, 2, v5
    v_and_b32_dpp v160, v156, v17 quad_perm:[2,2,2,2] row_mask:0xf bank_mask:0xf
    v_and_b32_dpp v161, v156, v18 quad_perm:[2,2,2,2] row_mask:0xf bank_mask:0xf
    v_and_b32_dpp v162, v157, v17 quad_perm:[2,2,2,2] row_mask:0xf bank_mask:0xf
    v_and_b32_dpp v163, v157, v18 quad_perm:[2,2,2,2] row_mask:0xf bank_mask:0xf
    v_and_b32_dpp v164, v158, v17 quad_perm:[2,2,2,2] row_mask:0xf bank_mask:0xf
    v_and_b32_dpp v165, v158, v18 quad_perm:[2,2,2,2] row_mask:0xf bank_mask:0xf
    v_and_b32_dpp v166, v159, v17 quad_perm:[2,2,2,2] row_mask:0xf bank_mask:0xf
    v_and_b32_dpp v167, v159, v18 quad_perm:[2,2,2,2] row_mask:0xf bank_mask:0xf
    s_waitcnt vmcnt(11)
    v_mfma_f32_16x16x16_bf16 v[24:27], v[160:161], a[224:225], v[24:27]
    v_mfma_f32_16x16x16_bf16 v[28:31], v[160:161], a[226:227], v[28:31]
    s_waitcnt vmcnt(10)
    v_mfma_f32_16x16x16_bf16 v[24:27], v[162:163], a[228:229], v[24:27]
    v_mfma_f32_16x16x16_bf16 v[28:31], v[162:163], a[230:231], v[28:31]
    s_waitcnt vmcnt(9)
    v_mfma_f32_16x16x16_bf16 v[24:27], v[164:165], a[232:233], v[24:27]
    v_mfma_f32_16x16x16_bf16 v[28:31], v[164:165], a[234:235], v[28:31]
    s_waitcnt vmcnt(8)
    v_mfma_f32_16x16x16_bf16 v[24:27], v[166:167], a[236:237], v[24:27]
    v_mfma_f32_16x16x16_bf16 v[28:31], v[166:167], a[238:239], v[28:31]
    v_and_b32_dpp v160, v156, v17 quad_perm:[3,3,3,3] row_mask:0xf bank_mask:0xf
    v_and_b32_dpp v161, v156, v18 quad_perm:[3,3,3,3] row_mask:0xf bank_mask:0xf
    v_and_b32_dpp v162, v157, v17 quad_perm:[3,3,3,3] row_mask:0xf bank_mask:0xf
    v_and_b32_dpp v163, v157, v18 quad_perm:[3,3,3,3] row_mask:0xf bank_mask:0xf
    v_and_b32_dpp v164, v158, v17 quad_perm:[3,3,3,3] row_mask:0xf bank_mask:0xf
    v_and_b32_dpp v165, v158, v18 quad_perm:[3,3,3,3] row_mask:0xf bank_mask:0xf
    v_and_b32_dpp v166, v159, v17 quad_perm:[3,3,3,3] row_mask:0xf bank_mask:0xf
    v_and_b32_dpp v167, v159, v18 quad_perm:[3,3,3,3] row_mask:0xf bank_mask:0xf
    s_waitcnt vmcnt(7)
    v_mfma_f32_16x16x16_bf16 v[24:27], v[160:161], a[240:241], v[24:27]
    v_mfma_f32_16x16x16_bf16 v[28:31], v[160:161], a[242:243], v[28:31]
    s_waitcnt vmcnt(6)
    v_mfma_f32_16x16x16_bf16 v[24:27], v[162:163], a[244:245], v[24:27]
    v_mfma_f32_16x16x16_bf16 v[28:31], v[162:163], a[246:247], v[28:31]
    s_waitcnt vmcnt(5)
    v_mfma_f32_16x16x16_bf16 v[24:27], v[164:165], a[248:249], v[24:27]
    v_mfma_f32_16x16x16_bf16 v[28:31], v[164:165], a[250:251], v[28:31]
    s_waitcnt vmcnt(4)
    v_mfma_f32_16x16x16_bf16 v[24:27], v[166:167], a[252:253], v[24:27]
    v_mfma_f32_16x16x16_bf16 v[28:31], v[166:167], a[254:255], v[28:31]
    s_lshl_b32 s68, s3, 8
    s_add_u32 s68, s68, 160256
    v_lshl_add_u32 v6, v1, 2, s68
    ds_write_b32 v6, v223
    v_mov_b32 v6, 160256
    s_nop 1
    ds_write_b128 v3, v[24:27]
    ds_write_b128 v3, v[28:31] offset:1024
    s_waitcnt lgkmcnt(0)
    s_barrier
    ds_read_b32 v223, v6
    ds_read_b64 v[160:161], v4 offset:0
    ds_read_b64 v[162:163], v4 offset:2048
    ds_read_b64 v[164:165], v4 offset:4096
    ds_read_b64 v[166:167], v4 offset:6144
    s_cmp_eq_u32 s83, 0
    s_waitcnt lgkmcnt(2)
    v_pk_add_f32 v[160:161], v[160:161], v[162:163]
    s_waitcnt lgkmcnt(0)
    v_pk_add_f32 v[164:165], v[164:165], v[166:167]
    v_pk_add_f32 v[160:161], v[160:161], v[164:165]
    v_cvt_pk_bf16_f32 v160, v160, v161
    s_cbranch_scc1 SLOW_9
    buffer_store_dword v160, v5, s[40:43], s67 offen
BACK_10:
    v_readfirstlane_b32 s86, v223
    s_nop 0
    s_and_b32 s86, s86, 127
    s_cmp_lt_u32 s86, 56
    s_cbranch_scc1 L_C
    s_sub_u32 s86, s86, 96
    s_cmp_lt_u32 s86, 32
    s_cbranch_scc1 L_E
    s_branch L_FIN
L_B:
    s_mov_b32 s7, s0
    s_sub_u32 s67, 13, s0
    s_min_u32 s67, s67, s0
    s_cmp_ge_u32 s67, 3
    s_addc_u32 s67, s67, 0
    s_lshl_b32 s67, s67, 1
    s_cmp_ge_u32 s0, 7
    s_addc_u32 s67, s67, 0
    s_sub_u32 s68, s0, 8
    s_cmp_ge_u32 s0, 14
    s_cselect_b32 s0, s68, s67
    s_lshl_b32 s71, s62, 13
    s_lshl_b32 s82, s3, 11
    s_add_u32 s71, s71, s82
    s_add_u32 s71, s71, 131072
    buffer_load_dwordx4 v[112:115], v2, s[40:43], s71 offen offset:0 sc1
    buffer_load_dwordx4 v[116:119], v2, s[40:43], s71 offen offset:1024 sc1
    s_mov_b32 s48, s12
    s_mov_b32 s49, s13
    s_mov_b32 s50, 0x400000
    s_mov_b32 s51, 0x20000
    v_lshrrev_b32 v3, 2, v1
    v_lshlrev_b32 v176, 10, v3
    v_lshl_add_u32 v176, v21, 4, v176
    s_lshl_b32 s70, s62, 19
    s_lshl_b32 s82, s3, 17
    s_add_u32 s70, s70, s82
    s_lshl_b32 s82, s0, 6
    s_add_u32 s70, s70, s82
    s_mov_b32 m0, s61
    v_lshlrev_b32 v177, 12, v22
    v_lshl_add_u32 v177, v19, 6, v177
    v_lshl_add_u32 v177, v21, 4, v177
    v_lshl_add_u32 v180, v19, 9, s61
    v_lshl_add_u32 v180, v22, 6, v180
    v_lshl_add_u32 v180, v21, 3, v180
    v_and_b32 v3, 1, v22
    s_lshl_b32 s67, s3, 9
    s_add_u32 s67, s67, 147456
    v_lshl_add_u32 v179, v21, 7, s67
    v_lshl_add_u32 v179, v19, 4, v179
    v_lshl_add_u32 v179, v3, 6, v179
    s_lshl_b32 s67, s3, 7
    s_add_u32 s67, s67, 147456
    v_add_u32 v178, s67, v2
    v_lshrrev_b32 v5, 3, v1
    v_and_b32 v6, 7, v1
    v_lshlrev_b32 v181, 10, v5
    v_lshl_add_u32 v181, v6, 4, v181
    s_mul_i32 s68, s7, 131072
    s_mul_i32 s69, s3, 32768
    s_lshl_b32 s82, s69, 0
    s_add_u32 s68, s68, s82
    s_lshl_b32 s82, s62, 19
    s_add_u32 s68, s68, s82
    s_add_u32 s68, s68, 384
    s_cmp_lt_u32 s7, 4
    s_cselect_b32 s68, s68, 536870912
    buffer_load_dwordx4 v[32:35], v181, s[48:51], s68 offen
    s_add_u32 s68, s68, 8192
    buffer_load_dwordx4 v[36:39], v181, s[48:51], s68 offen
    s_add_u32 s68, s68, 8192
    buffer_load_dwordx4 v[40:43], v181, s[48:51], s68 offen
    s_add_u32 s68, s68, 8192
    buffer_load_dwordx4 v[44:47], v181, s[48:51], s68 offen
    s_waitcnt vmcnt(13)
    buffer_load_dwordx4 v176, s[48:51], s70 offen  lds
    s_add_u32 m0, m0, 1024
    s_add_u32 s70, s70, 16384
    s_waitcnt vmcnt(13)
    buffer_load_dwordx4 v176, s[48:51], s70 offen  lds
    s_add_u32 m0, m0, 1024
    s_add_u32 s70, s70, 16384
    s_waitcnt vmcnt(13)
    buffer_load_dwordx4 v176, s[48:51], s70 offen  lds
    s_add_u32 m0, m0, 1024
    s_add_u32 s70, s70, 16384
    s_waitcnt vmcnt(13)
    buffer_load_dwordx4 v176, s[48:51], s70 offen  lds
    v_and_b32_dpp v160, v156, v17 quad_perm:[2,2,2,2] row_mask:0xf bank_mask:0xf
    v_and_b32_dpp v161, v156, v18 quad_perm:[2,2,2,2] row_mask:0xf bank_mask:0xf
    v_and_b32_dpp v162, v157, v17 quad_perm:[2,2,2,2] row_mask:0xf bank_mask:0xf
    v_and_b32_dpp v163, v157, v18 quad_perm:[2,2,2,2] row_mask:0xf bank_mask:0xf
    v_and_b32_dpp v164, v158, v17 quad_perm:[2,2,2,2] row_mask:0xf bank_mask:0xf
    v_and_b32_dpp v165, v158, v18 quad_perm:[2,2,2,2] row_mask:0xf bank_mask:0xf
    v_and_b32_dpp v166, v159, v17 quad_perm:[2,2,2,2] row_mask:0xf bank_mask:0xf
    v_and_b32_dpp v167, v159, v18 quad_perm:[2,2,2,2] row_mask:0xf bank_mask:0xf
    v_mfma_f32_16x16x16_bf16 v[24:27], v[160:161], a[224:225], v[24:27]
    v_mfma_f32_16x16x16_bf16 v[28:31], v[160:161], a[226:227], v[28:31]
    v_mfma_f32_16x16x16_bf16 v[24:27], v[162:163], a[228:229], v[24:27]
    v_mfma_f32_16x16x16_bf16 v[28:31], v[162:163], a[230:231], v[28:31]
    v_mfma_f32_16x16x16_bf16 v[24:27], v[164:165], a[232:233], v[24:27]
    v_mfma_f32_16x16x16_bf16 v[28:31], v[164:165], a[234:235], v[28:31]
    v_mfma_f32_16x16x16_bf16 v[24:27], v[166:167], a[236:237], v[24:27]
    v_mfma_f32_16x16x16_bf16 v[28:31], v[166:167], a[238:239], v[28:31]
    s_add_u32 m0, m0, 1024
    s_add_u32 s70, s70, 16384
    s_waitcnt vmcnt(13)
    buffer_load_dwordx4 v176, s[48:51], s70 offen  lds
    s_add_u32 m0, m0, 1024
    s_add_u32 s70, s70, 16384
    s_lshl_b32 s67, s3, 11
    s_add_u32 s67, s67, 152064
    v_add_u32 v3, s67, v2
    v_lshrrev_b32 v6, 2, v1
    v_bfe_u32 v5, v1, 1, 1
    v_and_b32 v7, 1, v1
    s_lshl_b32 s67, s3, 8
    s_add_u32 s67, s67, 152064
    v_lshl_add_u32 v4, v6, 4, s67
    v_lshl_add_u32 v4, v5, 10, v4
    v_lshl_add_u32 v4, v7, 3, v4
    s_lshl_b32 s67, s62, 15
    s_lshl_b32 s82, s65, 12
    s_add_u32 s67, s67, s82
    s_lshl_b32 s82, s3, 10
    s_add_u32 s67, s67, s82
    s_lshl_b32 s82, s64, 4
    s_add_u32 s67, s67, s82
    s_add_u32 s67, s67, 262144
    v_lshlrev_b32 v5, 6, v6
    v_lshl_add_u32 v5, v21, 2, v5
    v_and_b32_dpp v160, v156, v17 quad_perm:[3,3,3,3] row_mask:0xf bank_mask:0xf
    v_and_b32_dpp v161, v156, v18 quad_perm:[3,3,3,3] row_mask:0xf bank_mask:0xf
    v_and_b32_dpp v162, v157, v17 quad_perm:[3,3,3,3] row_mask:0xf bank_mask:0xf
    v_and_b32_dpp v163, v157, v18 quad_perm:[3,3,3,3] row_mask:0xf bank_mask:0xf
    v_and_b32_dpp v164, v158, v17 quad_perm:[3,3,3,3] row_mask:0xf bank_mask:0xf
    v_and_b32_dpp v165, v158, v18 quad_perm:[3,3,3,3] row_mask:0xf bank_mask:0xf
    v_and_b32_dpp v166, v159, v17 quad_perm:[3,3,3,3] row_mask:0xf bank_mask:0xf
    v_and_b32_dpp v167, v159, v18 quad_perm:[3,3,3,3] row_mask:0xf bank_mask:0xf
    v_mfma_f32_16x16x16_bf16 v[24:27], v[160:161], a[240:241], v[24:27]
    v_mfma_f32_16x16x16_bf16 v[28:31], v[160:161], a[242:243], v[28:31]
    s_waitcnt vmcnt(13)
    v_mfma_f32_16x16x16_bf16 v[24:27], v[162:163], a[244:245], v[24:27]
    v_mfma_f32_16x16x16_bf16 v[28:31], v[162:163], a[246:247], v[28:31]
    s_waitcnt vmcnt(12)
    v_mfma_f32_16x16x16_bf16 v[24:27], v[164:165], a[248:249], v[24:27]
    v_mfma_f32_16x16x16_bf16 v[28:31], v[164:165], a[250:251], v[28:31]
    s_waitcnt vmcnt(11)
    v_mfma_f32_16x16x16_bf16 v[24:27], v[166:167], a[252:253], v[24:27]
    v_mfma_f32_16x16x16_bf16 v[28:31], v[166:167], a[254:255], v[28:31]
    s_nop 6
    ds_write_b128 v3, v[24:27]
    ds_write_b128 v3, v[28:31] offset:1024
    s_waitcnt lgkmcnt(0)
    s_barrier
    ds_read_b64 v[160:161], v4 offset:0
    ds_read_b64 v[162:163], v4 offset:2048
    ds_read_b64 v[164:165], v4 offset:4096
    ds_read_b64 v[166:167], v4 offset:6144
    s_cmp_eq_u32 s83, 0
    s_waitcnt lgkmcnt(2)
    v_pk_add_f32 v[160:161], v[160:161], v[162:163]
    s_waitcnt lgkmcnt(0)
    v_pk_add_f32 v[164:165], v[164:165], v[166:167]
    v_pk_add_f32 v[160:161], v[160:161], v[164:165]
    v_cvt_pk_bf16_f32 v160, v160, v161
    s_cbranch_scc1 SLOW_11
    buffer_store_dword v160, v5, s[40:43], s67 offen
BACK_12:
    buffer_load_dwordx4 v176, s[48:51], s70 offen  lds
    s_add_u32 m0, m0, 1024
    s_add_u32 s70, s70, 16384
    buffer_load_dwordx4 v176, s[48:51], s70 offen  lds
    s_add_u32 m0, m0, 1024
    s_add_u32 s70, s70, 16384
    buffer_load_dwordx4 v176, s[48:51], s70 offen  lds
    s_waitcnt vmcnt(13)
    s_mov_b32 s84, 0
CHK_13:
    v_xor_b32 v3, s80, v114
    v_xor_b32 v5, s81, v115
    v_xor_b32 v4, s80, v118
    v_xor_b32 v6, s81, v119
    v_or_b32 v3, v3, v4
    v_or_b32 v5, v5, v6
    v_and_b32 v6, 0xfffffff0, v5
    v_or_b32 v3, v3, v6
    v_cmp_ne_u32 vcc, 0, v3
    s_cbranch_vccnz RETRY_15
OK_14:
    s_lshl_b32 s70, s62, 15
    s_lshl_b32 s82, s3, 10
    s_add_u32 s70, s70, s82
    s_add_u32 s70, s70, 262144
    s_add_u32 s71, s70, 16384
    s_mov_b32 s84, 0
    buffer_load_dwordx4 v[64:67], v177, s[40:43], s70 offen offset:0 sc1
    buffer_load_dwordx4 v[68:71], v177, s[40:43], s70 offen offset:256 sc1
    buffer_load_dwordx4 v[72:75], v177, s[40:43], s70 offen offset:512 sc1
    buffer_load_dwordx4 v[76:79], v177, s[40:43], s70 offen offset:768 sc1
    buffer_load_dwordx4 v[80:83], v177, s[40:43], s71 offen offset:0 sc1
    buffer_load_dwordx4 v[84:87], v177, s[40:43], s71 offen offset:256 sc1
    buffer_load_dwordx4 v[88:91], v177, s[40:43], s71 offen offset:512 sc1
    buffer_load_dwordx4 v[92:95], v177, s[40:43], s71 offen offset:768 sc1
    v_mov_b32 v120, v113
    v_mov_b32 v121, v117
    s_nop 0
    v_permlane16_swap_b32 v113, v120
    v_permlane16_swap_b32 v117, v121
    v_add_f32 v113, v113, v120
    v_add_f32 v117, v117, v121
    v_mov_b32 v120, v113
    v_mov_b32 v121, v117
    s_nop 0
    v_permlane32_swap_b32 v113, v120
    v_permlane32_swap_b32 v117, v121
    v_add_f32 v113, v113, v120
    v_add_f32 v117, v117, v121
    v_max_f32 v114, v112, v116
    s_nop 1
    v_max_f32_dpp v114, v114, v114 row_ror:8 row_mask:0xf bank_mask:0xf
    s_nop 1
    v_max_f32_dpp v114, v114, v114 row_ror:4 row_mask:0xf bank_mask:0xf
    v_sub_f32 v112, v112, v114
    v_sub_f32 v116, v116, v114
    v_mul_f32 v112, 0x3fb8aa3b, v112
    v_mul_f32 v116, 0x3fb8aa3b, v116
    v_exp_f32 v112, v112
    v_exp_f32 v116, v116
    v_mul_f32 v115, v112, v113
    v_fmac_f32 v115, v116, v117
    s_nop 1
    v_add_f32_dpp v115, v115, v115 row_ror:8 row_mask:0xf bank_mask:0xf
    s_nop 1
    v_add_f32_dpp v115, v115, v115 row_ror:4 row_mask:0xf bank_mask:0xf
    v_rcp_f32 v115, v115
    s_nop 0
    v_mul_f32 v112, v112, v115
    v_mul_f32 v116, v116, v115
    s_lshl_b32 s67, s62, 14
    s_lshl_b32 s82, s3, 11
    s_add_u32 s67, s67, s82
    s_lshl_b32 s82, s0, 7
    s_add_u32 s67, s67, s82
    s_add_u32 s67, s67, 524288
    s_add_u32 s68, s67, 8192
    s_waitcnt vmcnt(15)
    ds_read_b64_tr_b16 v[32:33], v180 offset:0
    ds_read_b64_tr_b16 v[34:35], v180 offset:256
    ds_read_b64_tr_b16 v[48:49], v180 offset:32
    ds_read_b64_tr_b16 v[50:51], v180 offset:288
    s_waitcnt vmcnt(13)
    ds_read_b64_tr_b16 v[36:37], v180 offset:2048
    ds_read_b64_tr_b16 v[38:39], v180 offset:2304
    ds_read_b64_tr_b16 v[52:53], v180 offset:2080
    ds_read_b64_tr_b16 v[54:55], v180 offset:2336
    s_waitcnt vmcnt(10)
    ds_read_b64_tr_b16 v[40:41], v180 offset:4096
    ds_read_b64_tr_b16 v[42:43], v180 offset:4352
    ds_read_b64_tr_b16 v[56:57], v180 offset:4128
    ds_read_b64_tr_b16 v[58:59], v180 offset:4384
    s_waitcnt lgkmcnt(4)
    s_waitcnt vmcnt(8)
    ds_read_b64_tr_b16 v[44:45], v180 offset:6144
    ds_read_b64_tr_b16 v[46:47], v180 offset:6400
    ds_read_b64_tr_b16 v[60:61], v180 offset:6176
    ds_read_b64_tr_b16 v[62:63], v180 offset:6432
    s_waitcnt lgkmcnt(0)
CHK_16:
    s_waitcnt vmcnt(7)
    v_max3_u32 v3, v64, v65, v66
    v_max_u32 v3, v3, v67
    s_waitcnt vmcnt(6)
    v_max3_u32 v3, v3, v68, v69
    v_max3_u32 v3, v3, v70, v71
    s_waitcnt vmcnt(5)
    v_max3_u32 v3, v3, v72, v73
    v_max3_u32 v3, v3, v74, v75
    s_waitcnt vmcnt(4)
    v_max3_u32 v3, v3, v76, v77
    v_max3_u32 v3, v3, v78, v79
    v_cmp_eq_u32 vcc, -1, v3
    s_cbranch_vccnz RETRY_18
OK_17:
    v_mfma_f32_16x16x32_bf16 v[96:99], v[32:35], v[64:67], 0
    v_mfma_f32_16x16x32_bf16 v[100:103], v[48:51], v[64:67], 0
    v_mfma_f32_16x16x32_bf16 v[96:99], v[36:39], v[68:71], v[96:99]
    v_mfma_f32_16x16x32_bf16 v[100:103], v[52:55], v[68:71], v[100:103]
    v_mfma_f32_16x16x32_bf16 v[96:99], v[40:43], v[72:75], v[96:99]
    v_mfma_f32_16x16x32_bf16 v[100:103], v[56:59], v[72:75], v[100:103]
    v_mfma_f32_16x16x32_bf16 v[96:99], v[44:47], v[76:79], v[96:99]
    v_mfma_f32_16x16x32_bf16 v[100:103], v[60:63], v[76:79], v[100:103]
CHK_19:
    s_waitcnt vmcnt(3)
    v_max3_u32 v3, v80, v81, v82
    v_max_u32 v3, v3, v83
    s_waitcnt vmcnt(2)
    v_max3_u32 v3, v3, v84, v85
    v_max3_u32 v3, v3, v86, v87
    s_waitcnt vmcnt(1)
    v_max3_u32 v3, v3, v88, v89
    v_max3_u32 v3, v3, v90, v91
    s_waitcnt vmcnt(0)
    v_max3_u32 v3, v3, v92, v93
    v_max3_u32 v3, v3, v94, v95
    v_cmp_eq_u32 vcc, -1, v3
    s_cbranch_vccnz RETRY_21
OK_20:
L_BPOST:
    v_mfma_f32_16x16x32_bf16 v[104:107], v[32:35], v[80:83], 0
    v_mfma_f32_16x16x32_bf16 v[108:111], v[48:51], v[80:83], 0
    v_mfma_f32_16x16x32_bf16 v[104:107], v[36:39], v[84:87], v[104:107]
    v_mfma_f32_16x16x32_bf16 v[108:111], v[52:55], v[84:87], v[108:111]
    v_mfma_f32_16x16x32_bf16 v[104:107], v[40:43], v[88:91], v[104:107]
    v_mfma_f32_16x16x32_bf16 v[108:111], v[56:59], v[88:91], v[108:111]
    v_mfma_f32_16x16x32_bf16 v[104:107], v[44:47], v[92:95], v[104:107]
    v_mfma_f32_16x16x32_bf16 v[108:111], v[60:63], v[92:95], v[108:111]
    v_pk_mul_f32 v[96:97], v[96:97], v[112:113] op_sel_hi:[1,0]
    v_pk_mul_f32 v[98:99], v[98:99], v[112:113] op_sel_hi:[1,0]
    v_pk_mul_f32 v[100:101], v[100:101], v[112:113] op_sel_hi:[1,0]
    v_pk_mul_f32 v[102:103], v[102:103], v[112:113] op_sel_hi:[1,0]
    s_nop 2
    v_pk_fma_f32 v[96:97], v[104:105], v[116:117], v[96:97] op_sel_hi:[1,0,1]
    v_pk_fma_f32 v[98:99], v[106:107], v[116:117], v[98:99] op_sel_hi:[1,0,1]
    v_pk_fma_f32 v[100:101], v[108:109], v[116:117], v[100:101] op_sel_hi:[1,0,1]
    v_pk_fma_f32 v[102:103], v[110:111], v[116:117], v[102:103] op_sel_hi:[1,0,1]
    v_add_f32_dpp v96, v96, v96 row_shl:4 row_mask:0xf bank_mask:0x5
    v_add_f32_dpp v97, v97, v97 row_shl:4 row_mask:0xf bank_mask:0x5
    v_add_f32_dpp v98, v98, v98 row_shl:4 row_mask:0xf bank_mask:0x5
    v_add_f32_dpp v99, v99, v99 row_shl:4 row_mask:0xf bank_mask:0x5
    v_add_f32_dpp v96, v100, v100 row_shr:4 row_mask:0xf bank_mask:0xa
    v_add_f32_dpp v97, v101, v101 row_shr:4 row_mask:0xf bank_mask:0xa
    v_add_f32_dpp v98, v102, v102 row_shr:4 row_mask:0xf bank_mask:0xa
    v_add_f32_dpp v99, v103, v103 row_shr:4 row_mask:0xf bank_mask:0xa
    v_add_f32_dpp v96, v96, v96 row_ror:8 row_mask:0xf bank_mask:0xf
    v_add_f32_dpp v97, v97, v97 row_ror:8 row_mask:0xf bank_mask:0xf
    v_add_f32_dpp v98, v98, v98 row_ror:8 row_mask:0xf bank_mask:0xf
    v_add_f32_dpp v99, v99, v99 row_ror:8 row_mask:0xf bank_mask:0xf
    s_mov_b32 exec_lo, 0x00ff00ff
    s_mov_b32 exec_hi, 0x00ff00ff
    ds_write_b128 v179, v[96:99]
    s_mov_b64 exec, 0xff
    s_waitcnt lgkmcnt(0)
    s_barrier
    ds_read_b128 v[64:67], v178 offset:0
    ds_read_b128 v[68:71], v178 offset:512
    ds_read_b128 v[72:75], v178 offset:1024
    ds_read_b128 v[76:79], v178 offset:1536
    s_waitcnt lgkmcnt(2)
    v_pk_add_f32 v[64:65], v[64:65], v[68:69]
    v_pk_add_f32 v[66:67], v[66:67], v[70:71]
    s_waitcnt lgkmcnt(0)
    v_pk_add_f32 v[72:73], v[72:73], v[76:77]
    v_pk_add_f32 v[74:75], v[74:75], v[78:79]
    v_pk_add_f32 v[64:65], v[64:65], v[72:73]
    v_pk_add_f32 v[66:67], v[66:67], v[74:75]
    v_and_or_b32 v64, v64, v23, s14
    v_and_or_b32 v65, v65, v23, s14
    v_and_or_b32 v66, v66, v23, s14
    v_and_or_b32 v67, v67, v23, s14
    buffer_store_dwordx4 v[64:67], v2, s[40:43], s67 offen sc1
    buffer_store_dwordx4 v[64:67], v2, s[40:43], s68 offen sc1
    s_branch L_FIN
L_C:
    s_mov_b32 s52, s20
    s_mov_b32 s53, s21
    s_mov_b32 s54, 0x1c0000
    s_mov_b32 s55, 0x20000
    s_mov_b32 s48, s16
    s_mov_b32 s49, s17
    s_mov_b32 s50, 0x1c0000
    s_mov_b32 s51, 0x20000
    v_lshrrev_b32 v3, 2, v1
    v_mul_u32_u24 v223, 3584, v3
    v_lshl_add_u32 v223, v21, 4, v223
    s_mul_i32 s70, s3, 458752
    s_lshl_b32 s82, s86, 6
    s_add_u32 s70, s70, s82
    s_lshl_b32 m0, s3, 13
    s_nop 0
    buffer_load_dwordx4 v223, s[48:51], s70 offen  lds
    s_add_u32 m0, m0, 1024
    s_add_u32 s70, s70, 57344
    buffer_load_dwordx4 v223, s[48:51], s70 offen  lds
    s_add_u32 m0, m0, 1024
    s_add_u32 s70, s70, 57344
    buffer_load_dwordx4 v223, s[48:51], s70 offen  lds
    s_add_u32 m0, m0, 1024
    s_add_u32 s70, s70, 57344
    buffer_load_dwordx4 v223, s[48:51], s70 offen  lds
    s_add_u32 m0, m0, 1024
    s_add_u32 s70, s70, 57344
    buffer_load_dwordx4 v223, s[48:51], s70 offen  lds
    s_add_u32 m0, m0, 1024
    s_add_u32 s70, s70, 57344
    buffer_load_dwordx4 v223, s[48:51], s70 offen  lds
    s_add_u32 m0, m0, 1024
    s_add_u32 s70, s70, 57344
    buffer_load_dwordx4 v223, s[48:51], s70 offen  lds
    s_add_u32 m0, m0, 1024
    s_add_u32 s70, s70, 57344
    buffer_load_dwordx4 v223, s[48:51], s70 offen  lds
    v_lshlrev_b32 v223, 10, v19
    v_lshl_add_u32 v223, v20, 4, v223
    s_lshl_b32 s70, s86, 15
    s_lshl_b32 s82, s3, 8
    s_add_u32 s70, s70, s82
    s_lshl_b32 s68, s3, 13
    s_add_u32 s68, s68, 32768
    s_mov_b32 m0, s68
    s_nop 0
    buffer_load_dwordx4 v223, s[52:55], s70 offen  lds
    s_add_u32 m0, m0, 1024
    s_add_u32 s70, s70, 4096
    buffer_load_dwordx4 v223, s[52:55], s70 offen  lds
    s_add_u32 m0, m0, 1024
    s_add_u32 s70, s70, 4096
    buffer_load_dwordx4 v223, s[52:55], s70 offen  lds
    s_add_u32 m0, m0, 1024
    s_add_u32 s70, s70, 4096
    buffer_load_dwordx4 v223, s[52:55], s70 offen  lds
    s_add_u32 m0, m0, 1024
    s_add_u32 s70, s70, 4096
    buffer_load_dwordx4 v223, s[52:55], s70 offen  lds
    s_add_u32 m0, m0, 1024
    s_add_u32 s70, s70, 4096
    buffer_load_dwordx4 v223, s[52:55], s70 offen  lds
    s_add_u32 m0, m0, 1024
    s_add_u32 s70, s70, 4096
    buffer_load_dwordx4 v223, s[52:55], s70 offen  lds
    s_add_u32 m0, m0, 1024
    s_add_u32 s70, s70, 4096
    buffer_load_dwordx4 v223, s[52:55], s70 offen  lds
    s_mov_b32 s56, s18
    s_mov_b32 s57, s19
    s_mov_b32 s58, 0xe00
    s_mov_b32 s59, 0x20000
    s_and_b32 s69, s3, 1
    v_lshlrev_b32 v6, 3, v19
    s_lshl_b32 s67, s86, 6
    s_lshl_b32 s82, s69, 5
    s_add_u32 s67, s67, s82
    buffer_load_dwordx2 v[248:249], v6, s[56:59], s67 offen
    s_lshl_b32 s67, s69, 5
    v_lshl_add_u32 v8, v19, 9, s67
    v_lshl_add_u32 v8, v22, 6, v8
    v_lshl_add_u32 v8, v21, 3, v8
    v_lshl_add_u32 v9, v19, 11, s68
    v_lshl_add_u32 v9, v22, 8, v9
    v_lshl_add_u32 v9, v21, 5, v9
    s_mul_i32 s68, s3, 1088
    s_add_u32 s68, s68, 147456
    v_lshl_add_u32 v10, v1, 3, s68
    v_mul_u32_u24 v11, 1088, v21
    v_lshl_add_u32 v11, v19, 4, v11
    v_add_u32 v11, 147456, v11
    v_mul_u32_u24 v7, 80, v21
    s_add_u32 s67, s67, 65536
    v_lshl_add_u32 v12, v19, 3, s67
    v_add_u32 v12, v12, v7
    v_mul_u32_u24 v7, 80, v22
    v_lshl_add_u32 v6, v19, 4, v7
    v_add_u32 v6, 65536, v6
    v_mov_b32 v7, 66560
    s_mov_b32 vcc_lo, 0x11111111
    s_mov_b32 vcc_hi, 0x11111111
    v_cndmask_b32 v13, v7, v6, vcc
    s_mov_b32 vcc_lo, 0x22222222
    s_mov_b32 vcc_hi, 0x22222222
    v_cndmask_b32 v14, v7, v6, vcc
    s_mov_b32 vcc_lo, 0x44444444
    s_mov_b32 vcc_hi, 0x44444444
    v_cndmask_b32 v15, v7, v6, vcc
    s_mov_b32 vcc_lo, 0x88888888
    s_mov_b32 vcc_hi, 0x88888888
    v_cndmask_b32 v16, v7, v6, vcc
    v_lshlrev_b32 v17, 11, v22
    v_lshl_add_u32 v17, v19, 6, v17
    v_lshl_add_u32 v17, v21, 4, v17
    s_lshl_b32 s67, s3, 11
    s_add_u32 s67, s67, 67584
    v_add_u32 v18, s67, v2
    s_lshl_b32 s67, s3, 9
    s_add_u32 s67, s67, 67584
    v_lshl_add_u32 v24, v22, 11, s67
    v_lshl_add_u32 v24, v19, 6, v24
    v_lshl_add_u32 v24, v21, 4, v24
    v_mov_b32 v144, 0
    v_mov_b32 v145, 0
    v_mov_b32 v146, 0
    v_mov_b32 v147, 0
    v_mov_b32 v148, 0
    v_mov_b32 v149, 0
    v_mov_b32 v150, 0
    v_mov_b32 v151, 0
    ds_write_b128 v7, v[144:147]
    s_waitcnt vmcnt(9)
    s_barrier
    s_cmp_ge_u32 s3, 2
    s_cbranch_scc1 L_CW1
    ds_read_b64_tr_b16 v[32:33], v8 offset:0
    ds_read_b64_tr_b16 v[34:35], v8 offset:256
    ds_read_b64_tr_b16 v[36:37], v8 offset:2048
    ds_read_b64_tr_b16 v[38:39], v8 offset:2304
    ds_read_b64_tr_b16 v[40:41], v8 offset:4096
    ds_read_b64_tr_b16 v[42:43], v8 offset:4352
    ds_read_b64_tr_b16 v[44:45], v8 offset:6144
    ds_read_b64_tr_b16 v[46:47], v8 offset:6400
    s_waitcnt lgkmcnt(4)
    ds_read_b64_tr_b16 v[48:49], v8 offset:8192
    ds_read_b64_tr_b16 v[50:51], v8 offset:8448
    ds_read_b64_tr_b16 v[52:53], v8 offset:10240
    ds_read_b64_tr_b16 v[54:55], v8 offset:10496
    ds_read_b64_tr_b16 v[56:57], v8 offset:12288
    ds_read_b64_tr_b16 v[58:59], v8 offset:12544
    ds_read_b64_tr_b16 v[60:61], v8 offset:14336
    ds_read_b64_tr_b16 v[62:63], v8 offset:14592
    s_waitcnt lgkmcnt(4)
    ds_read_b64_tr_b16 v[64:65], v8 offset:16384
    ds_read_b64_tr_b16 v[66:67], v8 offset:16640
    ds_read_b64_tr_b16 v[68:69], v8 offset:18432
    ds_read_b64_tr_b16 v[70:71], v8 offset:18688
    ds_read_b64_tr_b16 v[72:73], v8 offset:20480
    ds_read_b64_tr_b16 v[74:75], v8 offset:20736
    ds_read_b64_tr_b16 v[76:77], v8 offset:22528
    ds_read_b64_tr_b16 v[78:79], v8 offset:22784
    s_waitcnt lgkmcnt(4)
    ds_read_b64_tr_b16 v[80:81], v8 offset:24576
    ds_read_b64_tr_b16 v[82:83], v8 offset:24832
    ds_read_b64_tr_b16 v[84:85], v8 offset:26624
    ds_read_b64_tr_b16 v[86:87], v8 offset:26880
    ds_read_b64_tr_b16 v[88:89], v8 offset:28672
    ds_read_b64_tr_b16 v[90:91], v8 offset:28928
    ds_read_b64_tr_b16 v[92:93], v8 offset:30720
    ds_read_b64_tr_b16 v[94:95], v8 offset:30976
    s_waitcnt lgkmcnt(4)
L_CW1:
    s_lshl_b32 s72, s3, 11
    s_lshl_b32 s82, s87, 0
    s_add_u32 s72, s72, s82
    s_add_u32 s72, s72, 524288
    s_lshl_b32 s73, s3, 11
    s_lshl_b32 s82, s87, 0
    s_add_u32 s73, s73, s82
    s_add_u32 s73, s73, 557056
    s_lshl_b32 s74, s3, 11
    s_lshl_b32 s82, s87, 0
    s_add_u32 s74, s74, s82
    s_add_u32 s74, s74, 589824
    s_lshl_b32 s75, s3, 11
    s_lshl_b32 s82, s87, 0
    s_add_u32 s75, s75, s82
    s_add_u32 s75, s75, 622592
    s_lshl_b32 s76, s3, 11
    s_lshl_b32 s82, s87, 0
    s_add_u32 s76, s76, s82
    s_add_u32 s76, s76, 540672
    s_lshl_b32 s77, s3, 11
    s_lshl_b32 s82, s87, 0
    s_add_u32 s77, s77, s82
    s_add_u32 s77, s77, 573440
    s_lshl_b32 s78, s3, 11
    s_lshl_b32 s82, s87, 0
    s_add_u32 s78, s78, s82
    s_add_u32 s78, s78, 606208
    s_lshl_b32 s79, s3, 11
    s_lshl_b32 s82, s87, 0
    s_add_u32 s79, s79, s82
    s_add_u32 s79, s79, 638976
    s_lshr_b32 s68, s15, 5
    s_xor_b32 s68, s68, s62
    s_and_b32 s68, s68, 1
    s_lshl_b32 s68, s68, 14
    s_xor_b32 s72, s72, s68
    s_xor_b32 s73, s73, s68
    s_xor_b32 s74, s74, s68
    s_xor_b32 s75, s75, s68
    s_xor_b32 s76, s76, s68
    s_xor_b32 s77, s77, s68
    s_xor_b32 s78, s78, s68
    s_xor_b32 s79, s79, s68
    s_lshl_b32 s67, s86, 14
    s_lshl_b32 s82, s3, 9
    s_add_u32 s67, s67, s82
    s_add_u32 s67, s67, 1048576
    s_add_u32 s70, s67, 8192
    s_mov_b32 s84, 0
    buffer_load_dwordx4 v[160:163], v2, s[40:43], s72 offen offset:0 sc1
    buffer_load_dwordx4 v[164:167], v2, s[40:43], s72 offen offset:1024 sc1
    buffer_load_dwordx4 v[168:171], v2, s[40:43], s73 offen offset:0 sc1
    buffer_load_dwordx4 v[172:175], v2, s[40:43], s73 offen offset:1024 sc1
    buffer_load_dwordx4 v[176:179], v2, s[40:43], s74 offen offset:0 sc1
    buffer_load_dwordx4 v[180:183], v2, s[40:43], s74 offen offset:1024 sc1
    buffer_load_dwordx4 v[184:187], v2, s[40:43], s75 offen offset:0 sc1
    buffer_load_dwordx4 v[188:191], v2, s[40:43], s75 offen offset:1024 sc1
    buffer_load_dwordx4 v[192:195], v2, s[40:43], s76 offen offset:0 sc1
    buffer_load_dwordx4 v[196:199], v2, s[40:43], s76 offen offset:1024 sc1
    buffer_load_dwordx4 v[200:203], v2, s[40:43], s77 offen offset:0 sc1
    buffer_load_dwordx4 v[204:207], v2, s[40:43], s77 offen offset:1024 sc1
    buffer_load_dwordx4 v[208:211], v2, s[40:43], s78 offen offset:0 sc1
    buffer_load_dwordx4 v[212:215], v2, s[40:43], s78 offen offset:1024 sc1
    buffer_load_dwordx4 v[216:219], v2, s[40:43], s79 offen offset:0 sc1
    buffer_load_dwordx4 v[220:223], v2, s[40:43], s79 offen offset:1024 sc1
    s_waitcnt vmcnt(17)
    ds_read_b64_tr_b16 v[96:97], v9 offset:0
    ds_read_b64_tr_b16 v[98:99], v9 offset:1024
    ds_read_b64_tr_b16 v[100:101], v9 offset:8
    ds_read_b64_tr_b16 v[102:103], v9 offset:1032
    ds_read_b64_tr_b16 v[104:105], v9 offset:16
    ds_read_b64_tr_b16 v[106:107], v9 offset:1040
    ds_read_b64_tr_b16 v[108:109], v9 offset:24
    ds_read_b64_tr_b16 v[110:111], v9 offset:1048
    s_waitcnt lgkmcnt(4)
    ds_read_b64_tr_b16 v[112:113], v9 offset:128
    ds_read_b64_tr_b16 v[114:115], v9 offset:1152
    ds_read_b64_tr_b16 v[116:117], v9 offset:136
    ds_read_b64_tr_b16 v[118:119], v9 offset:1160
    ds_read_b64_tr_b16 v[120:121], v9 offset:144
    ds_read_b64_tr_b16 v[122:123], v9 offset:1168
    ds_read_b64_tr_b16 v[124:125], v9 offset:152
    ds_read_b64_tr_b16 v[126:127], v9 offset:1176
    s_waitcnt lgkmcnt(4)
    s_waitcnt vmcnt(16)
    v_lshlrev_b32 v128, 16, v240
    v_and_b32 v129, 0xffff0000, v240
    v_lshlrev_b32 v130, 16, v241
    v_and_b32 v131, 0xffff0000, v241
    v_lshlrev_b32 v132, 16, v242
    v_and_b32 v133, 0xffff0000, v242
    v_lshlrev_b32 v134, 16, v243
    v_and_b32 v135, 0xffff0000, v243
    v_mul_f32 v128, 0.5, v128
    v_mul_f32 v129, 0.5, v129
    v_mul_f32 v130, 0.5, v130
    v_mul_f32 v131, 0.5, v131
    v_mul_f32 v132, 0.5, v132
    v_mul_f32 v133, 0.5, v133
    v_mul_f32 v134, 0.5, v134
    v_mul_f32 v135, 0.5, v135
    v_mov_b32 v152, v128
    v_mov_b32 v153, v129
    v_mov_b32 v154, v130
    v_mov_b32 v155, v131
    v_mov_b32 v156, v132
    v_mov_b32 v157, v133
    v_mov_b32 v158, v134
    v_mov_b32 v159, v135
    v_lshlrev_b32 v136, 16, v244
    v_and_b32 v137, 0xffff0000, v244
    v_lshlrev_b32 v138, 16, v245
    v_and_b32 v139, 0xffff0000, v245
    v_lshlrev_b32 v140, 16, v246
    v_and_b32 v141, 0xffff0000, v246
    v_lshlrev_b32 v142, 16, v247
    v_and_b32 v143, 0xffff0000, v247
    v_lshlrev_b32 v224, 16, v248
    v_and_b32 v225, 0xffff0000, v248
    v_lshlrev_b32 v226, 16, v249
    v_and_b32 v227, 0xffff0000, v249
CHK_22:
    s_waitcnt vmcnt(15)
    v_xor_b32 v3, s14, v160
    v_bitop3_b32 v3, v3, v161, s14 bitop3:0xf6
    v_bitop3_b32 v3, v3, v162, s14 bitop3:0xf6
    v_bitop3_b32 v3, v3, v163, s14 bitop3:0xf6
    s_waitcnt vmcnt(14)
    v_bitop3_b32 v3, v3, v164, s14 bitop3:0xf6
    v_bitop3_b32 v3, v3, v165, s14 bitop3:0xf6
    v_bitop3_b32 v3, v3, v166, s14 bitop3:0xf6
    v_bitop3_b32 v3, v3, v167, s14 bitop3:0xf6
    v_cmp_ne_u32_sdwa vcc, v3, v0 src0_sel:BYTE_0 src1_sel:DWORD
    s_cbranch_vccnz RETRY_24
OK_23:
    v_xor_b32 v160, s14, v160
    v_xor_b32 v161, s14, v161
    v_xor_b32 v162, s14, v162
    v_xor_b32 v163, s14, v163
    v_xor_b32 v164, s14, v164
    v_xor_b32 v165, s14, v165
    v_xor_b32 v166, s14, v166
    v_xor_b32 v167, s14, v167
    v_pk_add_f32 v[128:129], v[128:129], v[160:161]
    v_pk_add_f32 v[130:131], v[130:131], v[162:163]
    v_pk_add_f32 v[132:133], v[132:133], v[164:165]
    v_pk_add_f32 v[134:135], v[134:135], v[166:167]
CHK_25:
    s_waitcnt vmcnt(13)
    v_xor_b32 v3, s14, v168
    v_bitop3_b32 v3, v3, v169, s14 bitop3:0xf6
    v_bitop3_b32 v3, v3, v170, s14 bitop3:0xf6
    v_bitop3_b32 v3, v3, v171, s14 bitop3:0xf6
    s_waitcnt vmcnt(12)
    v_bitop3_b32 v3, v3, v172, s14 bitop3:0xf6
    v_bitop3_b32 v3, v3, v173, s14 bitop3:0xf6
    v_bitop3_b32 v3, v3, v174, s14 bitop3:0xf6
    v_bitop3_b32 v3, v3, v175, s14 bitop3:0xf6
    v_cmp_ne_u32_sdwa vcc, v3, v0 src0_sel:BYTE_0 src1_sel:DWORD
    s_cbranch_vccnz RETRY_27
OK_26:
    v_xor_b32 v168, s14, v168
    v_xor_b32 v169, s14, v169
    v_xor_b32 v170, s14, v170
    v_xor_b32 v171, s14, v171
    v_xor_b32 v172, s14, v172
    v_xor_b32 v173, s14, v173
    v_xor_b32 v174, s14, v174
    v_xor_b32 v175, s14, v175
    v_pk_add_f32 v[128:129], v[128:129], v[168:169]
    v_pk_add_f32 v[130:131], v[130:131], v[170:171]
    v_pk_add_f32 v[132:133], v[132:133], v[172:173]
    v_pk_add_f32 v[134:135], v[134:135], v[174:175]
CHK_28:
    s_waitcnt vmcnt(11)
    v_xor_b32 v3, s14, v176
    v_bitop3_b32 v3, v3, v177, s14 bitop3:0xf6
    v_bitop3_b32 v3, v3, v178, s14 bitop3:0xf6
    v_bitop3_b32 v3, v3, v179, s14 bitop3:0xf6
    s_waitcnt vmcnt(10)
    v_bitop3_b32 v3, v3, v180, s14 bitop3:0xf6
    v_bitop3_b32 v3, v3, v181, s14 bitop3:0xf6
    v_bitop3_b32 v3, v3, v182, s14 bitop3:0xf6
    v_bitop3_b32 v3, v3, v183, s14 bitop3:0xf6
    v_cmp_ne_u32_sdwa vcc, v3, v0 src0_sel:BYTE_0 src1_sel:DWORD
    s_cbranch_vccnz RETRY_30
OK_29:
    v_xor_b32 v176, s14, v176
    v_xor_b32 v177, s14, v177
    v_xor_b32 v178, s14, v178
    v_xor_b32 v179, s14, v179
    v_xor_b32 v180, s14, v180
    v_xor_b32 v181, s14, v181
    v_xor_b32 v182, s14, v182
    v_xor_b32 v183, s14, v183
    v_pk_add_f32 v[128:129], v[128:129], v[176:177]
    v_pk_add_f32 v[130:131], v[130:131], v[178:179]
    v_pk_add_f32 v[132:133], v[132:133], v[180:181]
    v_pk_add_f32 v[134:135], v[134:135], v[182:183]
CHK_31:
    s_waitcnt vmcnt(9)
    v_xor_b32 v3, s14, v184
    v_bitop3_b32 v3, v3, v185, s14 bitop3:0xf6
    v_bitop3_b32 v3, v3, v186, s14 bitop3:0xf6
    v_bitop3_b32 v3, v3, v187, s14 bitop3:0xf6
    s_waitcnt vmcnt(8)
    v_bitop3_b32 v3, v3, v188, s14 bitop3:0xf6
    v_bitop3_b32 v3, v3, v189, s14 bitop3:0xf6
    v_bitop3_b32 v3, v3, v190, s14 bitop3:0xf6
    v_bitop3_b32 v3, v3, v191, s14 bitop3:0xf6
    v_cmp_ne_u32_sdwa vcc, v3, v0 src0_sel:BYTE_0 src1_sel:DWORD
    s_cbranch_vccnz RETRY_33
OK_32:
    v_xor_b32 v184, s14, v184
    v_xor_b32 v185, s14, v185
    v_xor_b32 v186, s14, v186
    v_xor_b32 v187, s14, v187
    v_xor_b32 v188, s14, v188
    v_xor_b32 v189, s14, v189
    v_xor_b32 v190, s14, v190
    v_xor_b32 v191, s14, v191
    v_pk_add_f32 v[128:129], v[128:129], v[184:185]
    v_pk_add_f32 v[130:131], v[130:131], v[186:187]
    v_pk_add_f32 v[132:133], v[132:133], v[188:189]
    v_pk_add_f32 v[134:135], v[134:135], v[190:191]
CHK_34:
    s_waitcnt vmcnt(7)
    v_xor_b32 v3, s14, v192
    v_bitop3_b32 v3, v3, v193, s14 bitop3:0xf6
    v_bitop3_b32 v3, v3, v194, s14 bitop3:0xf6
    v_bitop3_b32 v3, v3, v195, s14 bitop3:0xf6
    s_waitcnt vmcnt(6)
    v_bitop3_b32 v3, v3, v196, s14 bitop3:0xf6
    v_bitop3_b32 v3, v3, v197, s14 bitop3:0xf6
    v_bitop3_b32 v3, v3, v198, s14 bitop3:0xf6
    v_bitop3_b32 v3, v3, v199, s14 bitop3:0xf6
    v_cmp_ne_u32_sdwa vcc, v3, v0 src0_sel:BYTE_0 src1_sel:DWORD
    s_cbranch_vccnz RETRY_36
OK_35:
    v_xor_b32 v192, s14, v192
    v_xor_b32 v193, s14, v193
    v_xor_b32 v194, s14, v194
    v_xor_b32 v195, s14, v195
    v_xor_b32 v196, s14, v196
    v_xor_b32 v197, s14, v197
    v_xor_b32 v198, s14, v198
    v_xor_b32 v199, s14, v199
    v_pk_add_f32 v[152:153], v[152:153], v[192:193]
    v_pk_add_f32 v[154:155], v[154:155], v[194:195]
    v_pk_add_f32 v[156:157], v[156:157], v[196:197]
    v_pk_add_f32 v[158:159], v[158:159], v[198:199]
CHK_37:
    s_waitcnt vmcnt(5)
    v_xor_b32 v3, s14, v200
    v_bitop3_b32 v3, v3, v201, s14 bitop3:0xf6
    v_bitop3_b32 v3, v3, v202, s14 bitop3:0xf6
    v_bitop3_b32 v3, v3, v203, s14 bitop3:0xf6
    s_waitcnt vmcnt(4)
    v_bitop3_b32 v3, v3, v204, s14 bitop3:0xf6
    v_bitop3_b32 v3, v3, v205, s14 bitop3:0xf6
    v_bitop3_b32 v3, v3, v206, s14 bitop3:0xf6
    v_bitop3_b32 v3, v3, v207, s14 bitop3:0xf6
    v_cmp_ne_u32_sdwa vcc, v3, v0 src0_sel:BYTE_0 src1_sel:DWORD
    s_cbranch_vccnz RETRY_39
OK_38:
    v_xor_b32 v200, s14, v200
    v_xor_b32 v201, s14, v201
    v_xor_b32 v202, s14, v202
    v_xor_b32 v203, s14, v203
    v_xor_b32 v204, s14, v204
    v_xor_b32 v205, s14, v205
    v_xor_b32 v206, s14, v206
    v_xor_b32 v207, s14, v207
    v_pk_add_f32 v[152:153], v[152:153], v[200:201]
    v_pk_add_f32 v[154:155], v[154:155], v[202:203]
    v_pk_add_f32 v[156:157], v[156:157], v[204:205]
    v_pk_add_f32 v[158:159], v[158:159], v[206:207]
CHK_40:
    s_waitcnt vmcnt(3)
    v_xor_b32 v3, s14, v208
    v_bitop3_b32 v3, v3, v209, s14 bitop3:0xf6
    v_bitop3_b32 v3, v3, v210, s14 bitop3:0xf6
    v_bitop3_b32 v3, v3, v211, s14 bitop3:0xf6
    s_waitcnt vmcnt(2)
    v_bitop3_b32 v3, v3, v212, s14 bitop3:0xf6
    v_bitop3_b32 v3, v3, v213, s14 bitop3:0xf6
    v_bitop3_b32 v3, v3, v214, s14 bitop3:0xf6
    v_bitop3_b32 v3, v3, v215, s14 bitop3:0xf6
    v_cmp_ne_u32_sdwa vcc, v3, v0 src0_sel:BYTE_0 src1_sel:DWORD
    s_cbranch_vccnz RETRY_42
OK_41:
    v_xor_b32 v208, s14, v208
    v_xor_b32 v209, s14, v209
    v_xor_b32 v210, s14, v210
    v_xor_b32 v211, s14, v211
    v_xor_b32 v212, s14, v212
    v_xor_b32 v213, s14, v213
    v_xor_b32 v214, s14, v214
    v_xor_b32 v215, s14, v215
    v_pk_add_f32 v[152:153], v[152:153], v[208:209]
    v_pk_add_f32 v[154:155], v[154:155], v[210:211]
    v_pk_add_f32 v[156:157], v[156:157], v[212:213]
    v_pk_add_f32 v[158:159], v[158:159], v[214:215]
CHK_43:
    s_waitcnt vmcnt(1)
    v_xor_b32 v3, s14, v216
    v_bitop3_b32 v3, v3, v217, s14 bitop3:0xf6
    v_bitop3_b32 v3, v3, v218, s14 bitop3:0xf6
    v_bitop3_b32 v3, v3, v219, s14 bitop3:0xf6
    s_waitcnt vmcnt(0)
    v_bitop3_b32 v3, v3, v220, s14 bitop3:0xf6
    v_bitop3_b32 v3, v3, v221, s14 bitop3:0xf6
    v_bitop3_b32 v3, v3, v222, s14 bitop3:0xf6
    v_bitop3_b32 v3, v3, v223, s14 bitop3:0xf6
    v_cmp_ne_u32_sdwa vcc, v3, v0 src0_sel:BYTE_0 src1_sel:DWORD
    s_cbranch_vccnz RETRY_45
OK_44:
L_CPOST:
    v_xor_b32 v216, s14, v216
    v_xor_b32 v217, s14, v217
    v_xor_b32 v218, s14, v218
    v_xor_b32 v219, s14, v219
    v_xor_b32 v220, s14, v220
    v_xor_b32 v221, s14, v221
    v_xor_b32 v222, s14, v222
    v_xor_b32 v223, s14, v223
    v_pk_add_f32 v[152:153], v[152:153], v[216:217]
    v_pk_add_f32 v[154:155], v[154:155], v[218:219]
    v_pk_add_f32 v[156:157], v[156:157], v[220:221]
    v_pk_add_f32 v[158:159], v[158:159], v[222:223]
    v_pk_add_f32 v[128:129], v[128:129], v[152:153]
    v_pk_add_f32 v[130:131], v[130:131], v[154:155]
    v_pk_add_f32 v[132:133], v[132:133], v[156:157]
    v_pk_add_f32 v[134:135], v[134:135], v[158:159]
    v_pk_add_f32 v[160:161], v[128:129], v[130:131]
    v_pk_mul_f32 v[162:163], v[128:129], v[128:129]
    v_pk_add_f32 v[164:165], v[132:133], v[134:135]
    v_pk_fma_f32 v[162:163], v[130:131], v[130:131], v[162:163]
    v_pk_add_f32 v[160:161], v[160:161], v[164:165]
    v_pk_fma_f32 v[162:163], v[132:133], v[132:133], v[162:163]
    v_add_f32 v160, v160, v161
    v_pk_fma_f32 v[162:163], v[134:135], v[134:135], v[162:163]
    v_add_f32 v161, v162, v163
    v_add_f32_dpp v160, v160, v160 row_ror:8 row_mask:0xf bank_mask:0xf
    s_nop 0
    v_add_f32_dpp v161, v161, v161 row_ror:8 row_mask:0xf bank_mask:0xf
    v_add_f32_dpp v160, v160, v160 row_ror:4 row_mask:0xf bank_mask:0xf
    s_nop 0
    v_add_f32_dpp v161, v161, v161 row_ror:4 row_mask:0xf bank_mask:0xf
    v_add_f32_dpp v160, v160, v160 row_ror:2 row_mask:0xf bank_mask:0xf
    s_nop 0
    v_add_f32_dpp v161, v161, v161 row_ror:2 row_mask:0xf bank_mask:0xf
    v_add_f32_dpp v160, v160, v160 row_ror:1 row_mask:0xf bank_mask:0xf
    s_nop 0
    v_add_f32_dpp v161, v161, v161 row_ror:1 row_mask:0xf bank_mask:0xf
    v_mov_b32 v164, v160
    v_mov_b32 v165, v161
    s_nop 0
    v_permlane16_swap_b32 v160, v164
    v_permlane16_swap_b32 v161, v165
    v_add_f32 v160, v160, v164
    v_add_f32 v161, v161, v165
    v_mov_b32 v164, v160
    v_mov_b32 v165, v161
    s_nop 0
    v_permlane32_swap_b32 v160, v164
    v_permlane32_swap_b32 v161, v165
    v_add_f32 v160, v160, v164
    v_add_f32 v161, v161, v165
    v_mul_f32 v160, 0x3b000000, v160
    v_mul_f32 v161, 0x3b000000, v161
    v_fma_f32 v161, -v160, v160, v161
    v_max_f32 v161, 0, v161
    v_add_f32 v161, 0x3727c5ac, v161
    v_rsq_f32 v162, v161
    s_nop 0
    v_mul_f32 v164, -v160, v162
    v_pk_fma_f32 v[168:169], v[128:129], v[162:163], v[164:165] op_sel_hi:[1,0,0]
    v_pk_fma_f32 v[170:171], v[130:131], v[162:163], v[164:165] op_sel_hi:[1,0,0]
    v_pk_fma_f32 v[172:173], v[132:133], v[162:163], v[164:165] op_sel_hi:[1,0,0]
    v_pk_fma_f32 v[174:175], v[134:135], v[162:163], v[164:165] op_sel_hi:[1,0,0]
    v_cvt_pk_bf16_f32 v168, v168, v169
    v_cvt_pk_bf16_f32 v169, v170, v171
    v_cvt_pk_bf16_f32 v170, v172, v173
    v_cvt_pk_bf16_f32 v171, v174, v175
    ds_write_b64 v10, v[168:169]
    ds_write_b64 v10, v[170:171] offset:512
    s_waitcnt lgkmcnt(0)
    s_barrier
    s_cmp_lt_u32 s3, 2
    s_cbranch_scc1 L_C01
    v_pk_add_f32 v[136:137], v[136:137], v[128:129]
    v_pk_add_f32 v[138:139], v[138:139], v[130:131]
    v_pk_add_f32 v[140:141], v[140:141], v[132:133]
    v_pk_add_f32 v[142:143], v[142:143], v[134:135]
    ds_write_b128 v18, v[136:139]
    ds_write_b128 v18, v[140:143] offset:1024
    s_branch L_C23B
L_C01:
    ds_read_b128 v[160:163], v11 offset:0
    ds_read_b128 v[164:167], v11 offset:64
    ds_read_b128 v[168:171], v11 offset:128
    ds_read_b128 v[172:175], v11 offset:192
    ds_read_b128 v[176:179], v11 offset:256
    ds_read_b128 v[180:183], v11 offset:320
    ds_read_b128 v[184:187], v11 offset:384
    ds_read_b128 v[188:191], v11 offset:448
    ds_read_b128 v[192:195], v11 offset:512
    ds_read_b128 v[196:199], v11 offset:576
    ds_read_b128 v[200:203], v11 offset:640
    ds_read_b128 v[204:207], v11 offset:704
    v_pk_add_f32 v[136:137], v[136:137], v[128:129]
    v_pk_add_f32 v[138:139], v[138:139], v[130:131]
    v_pk_add_f32 v[140:141], v[140:141], v[132:133]
    v_pk_add_f32 v[142:143], v[142:143], v[134:135]
    s_waitcnt lgkmcnt(11)
    ds_read_b128 v[208:211], v11 offset:768
    v_mfma_f32_16x16x32_bf16 v[224:227], v[32:35], v[160:163], v[224:227]
    s_waitcnt lgkmcnt(11)
    ds_read_b128 v[212:215], v11 offset:832
    v_mfma_f32_16x16x32_bf16 v[224:227], v[36:39], v[164:167], v[224:227]
    s_waitcnt lgkmcnt(11)
    ds_read_b128 v[216:219], v11 offset:896
    v_mfma_f32_16x16x32_bf16 v[224:227], v[40:43], v[168:171], v[224:227]
    s_waitcnt lgkmcnt(11)
    ds_read_b128 v[220:223], v11 offset:960
    v_mfma_f32_16x16x32_bf16 v[224:227], v[44:47], v[172:175], v[224:227]
    s_waitcnt lgkmcnt(11)
    v_mfma_f32_16x16x32_bf16 v[224:227], v[48:51], v[176:179], v[224:227]
    s_waitcnt lgkmcnt(10)
    v_mfma_f32_16x16x32_bf16 v[224:227], v[52:55], v[180:183], v[224:227]
    s_waitcnt lgkmcnt(9)
    v_mfma_f32_16x16x32_bf16 v[224:227], v[56:59], v[184:187], v[224:227]
    s_waitcnt lgkmcnt(8)
    v_mfma_f32_16x16x32_bf16 v[224:227], v[60:63], v[188:191], v[224:227]
    s_waitcnt lgkmcnt(7)
    v_mfma_f32_16x16x32_bf16 v[224:227], v[64:67], v[192:195], v[224:227]
    s_waitcnt lgkmcnt(6)
    v_mfma_f32_16x16x32_bf16 v[224:227], v[68:71], v[196:199], v[224:227]
    s_waitcnt lgkmcnt(5)
    v_mfma_f32_16x16x32_bf16 v[224:227], v[72:75], v[200:203], v[224:227]
    s_waitcnt lgkmcnt(4)
    v_mfma_f32_16x16x32_bf16 v[224:227], v[76:79], v[204:207], v[224:227]
    s_waitcnt lgkmcnt(3)
    v_mfma_f32_16x16x32_bf16 v[224:227], v[80:83], v[208:211], v[224:227]
    s_waitcnt lgkmcnt(2)
    v_mfma_f32_16x16x32_bf16 v[224:227], v[84:87], v[212:215], v[224:227]
    s_waitcnt lgkmcnt(1)
    v_mfma_f32_16x16x32_bf16 v[224:227], v[88:91], v[216:219], v[224:227]
    s_waitcnt lgkmcnt(0)
    v_mfma_f32_16x16x32_bf16 v[224:227], v[92:95], v[220:223], v[224:227]
    ds_write_b128 v18, v[136:139]
    ds_write_b128 v18, v[140:143] offset:1024
    s_nop 5
    v_max_f32 v224, 0, v224
    v_max_f32 v225, 0, v225
    v_max_f32 v226, 0, v226
    v_max_f32 v227, 0, v227
    v_pk_mul_f32 v[224:225], v[224:225], v[224:225]
    v_pk_mul_f32 v[226:227], v[226:227], v[226:227]
    v_cvt_pk_bf16_f32 v228, v224, v225
    v_cvt_pk_bf16_f32 v229, v226, v227
    ds_write_b64 v12, v[228:229]
L_C23B:
    s_cmp_lg_u32 s86, 0
    s_waitcnt lgkmcnt(0)
    s_barrier
    s_cbranch_scc1 L_C2
    ds_read_b128 v[144:147], v24 offset:0
    ds_read_b128 v[148:151], v24 offset:256
L_C2:
    ds_read_b128 v[160:163], v13
    ds_read_b128 v[164:167], v14
    ds_read_b128 v[168:171], v15
    ds_read_b128 v[172:175], v16
    s_waitcnt lgkmcnt(3)
    v_mfma_f32_16x16x32_bf16 v[144:147], v[96:99], v[160:163], v[144:147]
    v_mfma_f32_16x16x32_bf16 v[148:151], v[112:115], v[160:163], v[148:151]
    s_waitcnt lgkmcnt(2)
    v_mfma_f32_16x16x32_bf16 v[144:147], v[100:103], v[164:167], v[144:147]
    v_mfma_f32_16x16x32_bf16 v[148:151], v[116:119], v[164:167], v[148:151]
    s_waitcnt lgkmcnt(1)
    v_mfma_f32_16x16x32_bf16 v[144:147], v[104:107], v[168:171], v[144:147]
    v_mfma_f32_16x16x32_bf16 v[148:151], v[120:123], v[168:171], v[148:151]
    s_waitcnt lgkmcnt(0)
    v_mfma_f32_16x16x32_bf16 v[144:147], v[108:111], v[172:175], v[144:147]
    v_mfma_f32_16x16x32_bf16 v[148:151], v[124:127], v[172:175], v[148:151]
    s_nop 6
    v_and_or_b32 v144, v144, v23, s14
    v_and_or_b32 v145, v145, v23, s14
    v_and_or_b32 v146, v146, v23, s14
    v_and_or_b32 v147, v147, v23, s14
    buffer_store_dwordx4 v[144:147], v17, s[40:43], s67 offen offset:0 sc1
    buffer_store_dwordx4 v[144:147], v17, s[40:43], s70 offen offset:0 sc1
    v_and_or_b32 v148, v148, v23, s14
    v_and_or_b32 v149, v149, v23, s14
    v_and_or_b32 v150, v150, v23, s14
    v_and_or_b32 v151, v151, v23, s14
    buffer_store_dwordx4 v[148:151], v17, s[40:43], s67 offen offset:256 sc1
    buffer_store_dwordx4 v[148:151], v17, s[40:43], s70 offen offset:256 sc1
    s_branch L_FIN
L_E:
    s_lshl_b32 s86, s86, 2
    s_lshl_b32 s82, s3, 0
    s_add_u32 s86, s86, s82
    s_mov_b32 s52, s24
    s_mov_b32 s53, s25
    s_mov_b32 s54, 0x1000
    s_mov_b32 s55, 0x20000
    v_lshrrev_b32 v7, 2, v1
    v_lshlrev_b32 v92, 3, v21
    v_lshlrev_b32 v95, 14, v7
    v_lshl_add_u32 v95, v21, 4, v95
    v_and_b32 v94, 0x1ffff, v95
    s_lshl_b32 s67, s86, 5
    s_lshl_b32 s72, s86, 6
    s_lshl_b32 s82, s87, 0
    s_add_u32 s72, s72, s82
    s_add_u32 s72, s72, 1048576
    s_lshl_b32 s73, s86, 6
    s_lshl_b32 s82, s87, 0
    s_add_u32 s73, s73, s82
    s_add_u32 s73, s73, 1310720
    s_lshl_b32 s74, s86, 6
    s_lshl_b32 s82, s87, 0
    s_add_u32 s74, s74, s82
    s_add_u32 s74, s74, 1572864
    s_lshl_b32 s75, s86, 6
    s_lshl_b32 s82, s87, 0
    s_add_u32 s75, s75, s82
    s_add_u32 s75, s75, 1835008
    s_mov_b32 s1, 0
    s_branch L_EPOST
L_EPOLL:
    s_mov_b32 s1, 1
    s_mov_b64 exec, -1
    s_mov_b32 s84, 0
    buffer_load_dwordx4 v[48:51], v95, s[40:43], s72 offen sc1
    buffer_load_dwordx4 v[52:55], v95, s[40:43], s73 offen sc1
    buffer_load_dwordx4 v[56:59], v95, s[40:43], s74 offen sc1
    buffer_load_dwordx4 v[60:63], v94, s[40:43], s75 offen sc1
CHK_46:
    s_waitcnt vmcnt(3)
    v_xor_b32 v3, s14, v48
    v_bitop3_b32 v3, v3, v49, s14 bitop3:0xf6
    v_bitop3_b32 v3, v3, v50, s14 bitop3:0xf6
    v_bitop3_b32 v3, v3, v51, s14 bitop3:0xf6
    s_waitcnt vmcnt(2)
    v_bitop3_b32 v3, v3, v52, s14 bitop3:0xf6
    v_bitop3_b32 v3, v3, v53, s14 bitop3:0xf6
    v_bitop3_b32 v3, v3, v54, s14 bitop3:0xf6
    v_bitop3_b32 v3, v3, v55, s14 bitop3:0xf6
    s_waitcnt vmcnt(1)
    v_bitop3_b32 v3, v3, v56, s14 bitop3:0xf6
    v_bitop3_b32 v3, v3, v57, s14 bitop3:0xf6
    v_bitop3_b32 v3, v3, v58, s14 bitop3:0xf6
    v_bitop3_b32 v3, v3, v59, s14 bitop3:0xf6
    s_waitcnt vmcnt(0)
    v_bitop3_b32 v3, v3, v60, s14 bitop3:0xf6
    v_bitop3_b32 v3, v3, v61, s14 bitop3:0xf6
    v_bitop3_b32 v3, v3, v62, s14 bitop3:0xf6
    v_bitop3_b32 v3, v3, v63, s14 bitop3:0xf6
    v_cmp_ne_u32_sdwa vcc, v3, v0 src0_sel:BYTE_0 src1_sel:DWORD
    s_cbranch_vccnz RETRY_48
OK_47:
L_EPOST:
    v_xor_b32 v48, s14, v48
    v_xor_b32 v49, s14, v49
    v_xor_b32 v50, s14, v50
    v_xor_b32 v51, s14, v51
    v_xor_b32 v52, s14, v52
    v_xor_b32 v53, s14, v53
    v_xor_b32 v54, s14, v54
    v_xor_b32 v55, s14, v55
    v_xor_b32 v56, s14, v56
    v_xor_b32 v57, s14, v57
    v_xor_b32 v58, s14, v58
    v_xor_b32 v59, s14, v59
    v_xor_b32 v60, s14, v60
    v_xor_b32 v61, s14, v61
    v_xor_b32 v62, s14, v62
    v_xor_b32 v63, s14, v63
    v_pk_add_f32 v[48:49], v[48:49], v[52:53]
    v_pk_add_f32 v[50:51], v[50:51], v[54:55]
    s_mov_b32 exec_hi, 0
    v_pk_add_f32 v[56:57], v[56:57], v[60:61]
    v_pk_add_f32 v[58:59], v[58:59], v[62:63]
    s_mov_b32 exec_hi, -1
    v_pk_add_f32 v[48:49], v[48:49], v[56:57]
    v_pk_add_f32 v[50:51], v[50:51], v[58:59]
    s_nop 0
    v_add_f32_dpp v48, v48, v48 row_ror:4 row_mask:0xf bank_mask:0xf
    v_add_f32_dpp v49, v49, v49 row_ror:4 row_mask:0xf bank_mask:0xf
    v_add_f32_dpp v50, v50, v50 row_ror:4 row_mask:0xf bank_mask:0xf
    v_add_f32_dpp v51, v51, v51 row_ror:4 row_mask:0xf bank_mask:0xf
    v_add_f32_dpp v48, v48, v48 row_ror:8 row_mask:0xf bank_mask:0xf
    v_add_f32_dpp v49, v49, v49 row_ror:8 row_mask:0xf bank_mask:0xf
    v_add_f32_dpp v50, v50, v50 row_ror:8 row_mask:0xf bank_mask:0xf
    v_add_f32_dpp v51, v51, v51 row_ror:8 row_mask:0xf bank_mask:0xf
    v_mov_b32 v52, v48
    v_mov_b32 v53, v49
    v_mov_b32 v54, v50
    v_mov_b32 v55, v51
    v_permlane16_swap_b32 v48, v52
    v_permlane16_swap_b32 v49, v53
    v_permlane16_swap_b32 v50, v54
    v_permlane16_swap_b32 v51, v55
    v_add_f32 v48, v48, v52
    v_add_f32 v49, v49, v53
    v_add_f32 v50, v50, v54
    v_add_f32 v51, v51, v55
    v_mov_b32 v52, v48
    v_mov_b32 v53, v49
    v_mov_b32 v54, v50
    v_mov_b32 v55, v51
    v_permlane32_swap_b32 v48, v52
    v_permlane32_swap_b32 v49, v53
    v_permlane32_swap_b32 v50, v54
    v_permlane32_swap_b32 v51, v55
    v_add_f32 v48, v48, v52
    v_add_f32 v49, v49, v53
    v_add_f32 v50, v50, v54
    v_add_f32 v51, v51, v55
    s_mov_b64 exec, 15
    v_cvt_pk_bf16_f32 v48, v48, v49
    v_cvt_pk_bf16_f32 v49, v50, v51
    s_cmp_eq_u32 s1, 0
    s_cbranch_scc1 L_EPOLL
    buffer_store_dwordx2 v[48:49], v92, s[52:55], s67 offen
    s_cmp_lg_u32 s86, 0
    s_cbranch_scc1 L_E2
    s_mov_b64 exec, 1
    v_mov_b32 v52, s30
    v_mov_b32 v53, s31
    buffer_store_dwordx2 v[52:53], v92, s[40:43], 0 offen offset:0
L_E2:
L_FIN:
    s_endpgm
L_QRETRY:
    s_add_u32 s84, s84, 1
    s_cmp_ge_u32 s84, 524288
    s_cbranch_scc1 L_QOK
    buffer_load_dwordx4 v[168:171], v172, s[40:43], s70 offen sc1
    s_waitcnt vmcnt(0)
    s_branch L_QCHK
SLOW_1:
    buffer_store_dwordx4 v[200:203], v3, s[40:43], s67 offen sc1
    s_branch BACK_2
SLOW_3:
    buffer_store_dwordx4 v[192:195], v3, s[40:43], s67 offen sc1
    s_branch BACK_4
SLOW_9:
    buffer_store_dword v160, v5, s[40:43], s67 offen sc1
    s_branch BACK_10
SLOW_11:
    buffer_store_dword v160, v5, s[40:43], s67 offen sc1
    s_branch BACK_12
RETRY_15:
    s_add_u32 s84, s84, 1
    s_cmp_ge_u32 s84, 524288
    s_cbranch_scc1 OK_14
    buffer_load_dwordx4 v[112:115], v2, s[40:43], s71 offen offset:0 sc1
    buffer_load_dwordx4 v[116:119], v2, s[40:43], s71 offen offset:1024 sc1
    s_waitcnt vmcnt(0)
    s_branch CHK_13
RETRY_18:
    s_add_u32 s84, s84, 1
    s_cmp_ge_u32 s84, 524288
    s_cbranch_scc1 OK_17
    s_mov_b64 exec, vcc
    buffer_load_dwordx4 v[64:67], v177, s[40:43], s70 offen offset:0 sc1
    buffer_load_dwordx4 v[68:71], v177, s[40:43], s70 offen offset:256 sc1
    buffer_load_dwordx4 v[72:75], v177, s[40:43], s70 offen offset:512 sc1
    buffer_load_dwordx4 v[76:79], v177, s[40:43], s70 offen offset:768 sc1
    s_mov_b64 exec, -1
    s_waitcnt vmcnt(4)
    v_cmp_eq_u32 s[4:5], -1, v80
    v_cmp_eq_u32 s[6:7], -1, v84
    v_cmp_eq_u32 s[8:9], -1, v88
    v_cmp_eq_u32 s[10:11], -1, v92
    s_mov_b64 vcc, s[4:5]
    s_or_b64 vcc, vcc, s[6:7]
    s_or_b64 vcc, vcc, s[8:9]
    s_or_b64 vcc, vcc, s[10:11]
    s_cbranch_scc0 TIGHT_49
    s_mov_b64 exec, s[4:5]
    buffer_load_dwordx4 v[80:83], v177, s[40:43], s71 offen offset:0 sc1
    s_mov_b64 exec, s[6:7]
    buffer_load_dwordx4 v[84:87], v177, s[40:43], s71 offen offset:256 sc1
    s_mov_b64 exec, s[8:9]
    buffer_load_dwordx4 v[88:91], v177, s[40:43], s71 offen offset:512 sc1
    s_mov_b64 exec, s[10:11]
    buffer_load_dwordx4 v[92:95], v177, s[40:43], s71 offen offset:768 sc1
    s_mov_b64 exec, -1
    s_branch CHK_16
AGAIN_50:
    s_add_u32 s84, s84, 1
    s_cmp_ge_u32 s84, 524288
    s_cbranch_scc1 OK_17
    s_mov_b64 exec, vcc
    buffer_load_dwordx4 v[64:67], v177, s[40:43], s70 offen offset:0 sc1
    buffer_load_dwordx4 v[68:71], v177, s[40:43], s70 offen offset:256 sc1
    buffer_load_dwordx4 v[72:75], v177, s[40:43], s70 offen offset:512 sc1
    buffer_load_dwordx4 v[76:79], v177, s[40:43], s70 offen offset:768 sc1
    s_mov_b64 exec, -1
TIGHT_49:
    s_waitcnt vmcnt(3)
    v_max3_u32 v3, v64, v65, v66
    v_max_u32 v3, v3, v67
    s_waitcnt vmcnt(2)
    v_max3_u32 v3, v3, v68, v69
    v_max3_u32 v3, v3, v70, v71
    s_waitcnt vmcnt(1)
    v_max3_u32 v3, v3, v72, v73
    v_max3_u32 v3, v3, v74, v75
    s_waitcnt vmcnt(0)
    v_max3_u32 v3, v3, v76, v77
    v_max3_u32 v3, v3, v78, v79
    v_cmp_eq_u32 vcc, -1, v3
    s_cbranch_vccnz AGAIN_50
    s_branch OK_17
RETRY_21:
    s_add_u32 s84, s84, 1
    s_cmp_ge_u32 s84, 524288
    s_cbranch_scc1 OK_20
    s_mov_b64 exec, vcc
    buffer_load_dwordx4 v[80:83], v177, s[40:43], s71 offen offset:0 sc1
    buffer_load_dwordx4 v[84:87], v177, s[40:43], s71 offen offset:256 sc1
    buffer_load_dwordx4 v[88:91], v177, s[40:43], s71 offen offset:512 sc1
    buffer_load_dwordx4 v[92:95], v177, s[40:43], s71 offen offset:768 sc1
    s_mov_b64 exec, -1
    s_branch CHK_19
RETRY_24:
    s_add_u32 s84, s84, 1
    s_cmp_ge_u32 s84, 524288
    s_cbranch_scc1 OK_23
    buffer_load_dwordx4 v[160:163], v2, s[40:43], s72 offen offset:0 sc1
    buffer_load_dwordx4 v[164:167], v2, s[40:43], s72 offen offset:1024 sc1
    buffer_load_dwordx4 v[168:171], v2, s[40:43], s73 offen offset:0 sc1
    buffer_load_dwordx4 v[172:175], v2, s[40:43], s73 offen offset:1024 sc1
    buffer_load_dwordx4 v[176:179], v2, s[40:43], s74 offen offset:0 sc1
    buffer_load_dwordx4 v[180:183], v2, s[40:43], s74 offen offset:1024 sc1
    buffer_load_dwordx4 v[184:187], v2, s[40:43], s75 offen offset:0 sc1
    buffer_load_dwordx4 v[188:191], v2, s[40:43], s75 offen offset:1024 sc1
    buffer_load_dwordx4 v[192:195], v2, s[40:43], s76 offen offset:0 sc1
    buffer_load_dwordx4 v[196:199], v2, s[40:43], s76 offen offset:1024 sc1
    buffer_load_dwordx4 v[200:203], v2, s[40:43], s77 offen offset:0 sc1
    buffer_load_dwordx4 v[204:207], v2, s[40:43], s77 offen offset:1024 sc1
    buffer_load_dwordx4 v[208:211], v2, s[40:43], s78 offen offset:0 sc1
    buffer_load_dwordx4 v[212:215], v2, s[40:43], s78 offen offset:1024 sc1
    buffer_load_dwordx4 v[216:219], v2, s[40:43], s79 offen offset:0 sc1
    buffer_load_dwordx4 v[220:223], v2, s[40:43], s79 offen offset:1024 sc1
    s_branch CHK_22
RETRY_27:
    s_add_u32 s84, s84, 1
    s_cmp_ge_u32 s84, 524288
    s_cbranch_scc1 OK_26
    buffer_load_dwordx4 v[168:171], v2, s[40:43], s73 offen offset:0 sc1
    buffer_load_dwordx4 v[172:175], v2, s[40:43], s73 offen offset:1024 sc1
    buffer_load_dwordx4 v[176:179], v2, s[40:43], s74 offen offset:0 sc1
    buffer_load_dwordx4 v[180:183], v2, s[40:43], s74 offen offset:1024 sc1
    buffer_load_dwordx4 v[184:187], v2, s[40:43], s75 offen offset:0 sc1
    buffer_load_dwordx4 v[188:191], v2, s[40:43], s75 offen offset:1024 sc1
    buffer_load_dwordx4 v[192:195], v2, s[40:43], s76 offen offset:0 sc1
    buffer_load_dwordx4 v[196:199], v2, s[40:43], s76 offen offset:1024 sc1
    buffer_load_dwordx4 v[200:203], v2, s[40:43], s77 offen offset:0 sc1
    buffer_load_dwordx4 v[204:207], v2, s[40:43], s77 offen offset:1024 sc1
    buffer_load_dwordx4 v[208:211], v2, s[40:43], s78 offen offset:0 sc1
    buffer_load_dwordx4 v[212:215], v2, s[40:43], s78 offen offset:1024 sc1
    buffer_load_dwordx4 v[216:219], v2, s[40:43], s79 offen offset:0 sc1
    buffer_load_dwordx4 v[220:223], v2, s[40:43], s79 offen offset:1024 sc1
    s_branch CHK_25
RETRY_30:
    s_add_u32 s84, s84, 1
    s_cmp_ge_u32 s84, 524288
    s_cbranch_scc1 OK_29
    buffer_load_dwordx4 v[176:179], v2, s[40:43], s74 offen offset:0 sc1
    buffer_load_dwordx4 v[180:183], v2, s[40:43], s74 offen offset:1024 sc1
    buffer_load_dwordx4 v[184:187], v2, s[40:43], s75 offen offset:0 sc1
    buffer_load_dwordx4 v[188:191], v2, s[40:43], s75 offen offset:1024 sc1
    buffer_load_dwordx4 v[192:195], v2, s[40:43], s76 offen offset:0 sc1
    buffer_load_dwordx4 v[196:199], v2, s[40:43], s76 offen offset:1024 sc1
    buffer_load_dwordx4 v[200:203], v2, s[40:43], s77 offen offset:0 sc1
    buffer_load_dwordx4 v[204:207], v2, s[40:43], s77 offen offset:1024 sc1
    buffer_load_dwordx4 v[208:211], v2, s[40:43], s78 offen offset:0 sc1
    buffer_load_dwordx4 v[212:215], v2, s[40:43], s78 offen offset:1024 sc1
    buffer_load_dwordx4 v[216:219], v2, s[40:43], s79 offen offset:0 sc1
    buffer_load_dwordx4 v[220:223], v2, s[40:43], s79 offen offset:1024 sc1
    s_branch CHK_28
RETRY_33:
    s_add_u32 s84, s84, 1
    s_cmp_ge_u32 s84, 524288
    s_cbranch_scc1 OK_32
    buffer_load_dwordx4 v[184:187], v2, s[40:43], s75 offen offset:0 sc1
    buffer_load_dwordx4 v[188:191], v2, s[40:43], s75 offen offset:1024 sc1
    buffer_load_dwordx4 v[192:195], v2, s[40:43], s76 offen offset:0 sc1
    buffer_load_dwordx4 v[196:199], v2, s[40:43], s76 offen offset:1024 sc1
    buffer_load_dwordx4 v[200:203], v2, s[40:43], s77 offen offset:0 sc1
    buffer_load_dwordx4 v[204:207], v2, s[40:43], s77 offen offset:1024 sc1
    buffer_load_dwordx4 v[208:211], v2, s[40:43], s78 offen offset:0 sc1
    buffer_load_dwordx4 v[212:215], v2, s[40:43], s78 offen offset:1024 sc1
    buffer_load_dwordx4 v[216:219], v2, s[40:43], s79 offen offset:0 sc1
    buffer_load_dwordx4 v[220:223], v2, s[40:43], s79 offen offset:1024 sc1
    s_branch CHK_31
RETRY_36:
    s_add_u32 s84, s84, 1
    s_cmp_ge_u32 s84, 524288
    s_cbranch_scc1 OK_35
    buffer_load_dwordx4 v[192:195], v2, s[40:43], s76 offen offset:0 sc1
    buffer_load_dwordx4 v[196:199], v2, s[40:43], s76 offen offset:1024 sc1
    buffer_load_dwordx4 v[200:203], v2, s[40:43], s77 offen offset:0 sc1
    buffer_load_dwordx4 v[204:207], v2, s[40:43], s77 offen offset:1024 sc1
    buffer_load_dwordx4 v[208:211], v2, s[40:43], s78 offen offset:0 sc1
    buffer_load_dwordx4 v[212:215], v2, s[40:43], s78 offen offset:1024 sc1
    buffer_load_dwordx4 v[216:219], v2, s[40:43], s79 offen offset:0 sc1
    buffer_load_dwordx4 v[220:223], v2, s[40:43], s79 offen offset:1024 sc1
    s_branch CHK_34
RETRY_39:
    s_add_u32 s84, s84, 1
    s_cmp_ge_u32 s84, 524288
    s_cbranch_scc1 OK_38
    buffer_load_dwordx4 v[200:203], v2, s[40:43], s77 offen offset:0 sc1
    buffer_load_dwordx4 v[204:207], v2, s[40:43], s77 offen offset:1024 sc1
    buffer_load_dwordx4 v[208:211], v2, s[40:43], s78 offen offset:0 sc1
    buffer_load_dwordx4 v[212:215], v2, s[40:43], s78 offen offset:1024 sc1
    buffer_load_dwordx4 v[216:219], v2, s[40:43], s79 offen offset:0 sc1
    buffer_load_dwordx4 v[220:223], v2, s[40:43], s79 offen offset:1024 sc1
    s_branch CHK_37
RETRY_42:
    s_add_u32 s84, s84, 1
    s_cmp_ge_u32 s84, 524288
    s_cbranch_scc1 OK_41
    buffer_load_dwordx4 v[208:211], v2, s[40:43], s78 offen offset:0 sc1
    buffer_load_dwordx4 v[212:215], v2, s[40:43], s78 offen offset:1024 sc1
    buffer_load_dwordx4 v[216:219], v2, s[40:43], s79 offen offset:0 sc1
    buffer_load_dwordx4 v[220:223], v2, s[40:43], s79 offen offset:1024 sc1
    s_branch CHK_40
RETRY_45:
    s_add_u32 s84, s84, 1
    s_cmp_ge_u32 s84, 524288
    s_cbranch_scc1 OK_44
    buffer_load_dwordx4 v[216:219], v2, s[40:43], s79 offen offset:0 sc1
    buffer_load_dwordx4 v[220:223], v2, s[40:43], s79 offen offset:1024 sc1
    s_branch CHK_43
RETRY_48:
    s_add_u32 s84, s84, 1
    s_cmp_ge_u32 s84, 524288
    s_cbranch_scc1 OK_47
    s_mov_b64 exec, vcc
    buffer_load_dwordx4 v[48:51], v95, s[40:43], s72 offen sc1
    buffer_load_dwordx4 v[52:55], v95, s[40:43], s73 offen sc1
    buffer_load_dwordx4 v[56:59], v95, s[40:43], s74 offen sc1
    buffer_load_dwordx4 v[60:63], v94, s[40:43], s75 offen sc1
    s_mov_b64 exec, -1
    s_branch CHK_46
L_END:
    s_endpgm
.section .rodata,"a"
.p2align 6
.amdhsa_kernel sequential_preLN__gqa_block_cached__dense_activation_squared_relu__decode_kernel
  .amdhsa_next_free_vgpr 512
  .amdhsa_next_free_sgpr 102
  .amdhsa_accum_offset 256
  .amdhsa_group_segment_fixed_size 0
  .amdhsa_kernarg_size 104
  .amdhsa_user_sgpr_count 2
  .amdhsa_user_sgpr_kernarg_segment_ptr 1
  .amdhsa_system_sgpr_workgroup_id_x 1
  .amdhsa_float_denorm_mode_32 3
.end_amdhsa_kernel
```
